```python
import torch

def _softmax(x, axis=-1):
    return torch.softmax(x, dim=axis)
def _gelu(x):
    return torch.nn.functional.gelu(x, approximate="tanh")
def _silu(x):
    return torch.nn.functional.silu(x)
def _sigmoid(x):
    return torch.sigmoid(x)
def _layernorm(x, axis=-1, eps=1e-5):
    m = x.mean(dim=axis, keepdim=True)
    v = x.var(dim=axis, keepdim=True, unbiased=False)
    return (x - m) / torch.sqrt(v + eps)
def _scatter_add(tgt, idx, src, axis=0):
    return tgt.clone().index_add_(axis, idx, src)
def _segment_sum(src, seg, n):
    out = torch.zeros((n,) + src.shape[1:], dtype=src.dtype)
    return out.index_add_(0, seg, src)
def _pad(x, pw):
    flat = tuple(v for pair in reversed(pw) for v in pair)
    return torch.nn.functional.pad(x, flat)

kernel_name = 'gated_mix__ssm_conv_s4d__dense_activation_relu__prompt'

def setup_inputs():

    _w = (lambda a: (lambda t: t.to(torch.bfloat16) if t.is_floating_point() else t)(torch.as_tensor(a)))
    def _A_setup():
        Bsz, L, D, N = 1, 2048, 640, 128
        return {
            "u": _w((lambda *s: torch.randn(*s, dtype=torch.bfloat16) * 0.05)(Bsz, L, D)),
            "log_A_real": _w((lambda *s: torch.randn(*s, dtype=torch.bfloat16) * 6.4)(D, N) * 0.5),
            "A_imag": _w((lambda *s: torch.randn(*s, dtype=torch.bfloat16) * 0.2)(D, N) * 3.14),
            "C_real": _w((lambda *s: torch.randn(*s, dtype=torch.bfloat16) * 0.8)(D, N) / N ** 0.5),
            "C_imag": _w((lambda *s: torch.randn(*s, dtype=torch.bfloat16) * 0.8)(D, N) / N ** 0.5),
            "log_dt": _w((lambda *s: torch.randn(*s, dtype=torch.bfloat16) * 0.2)(D) * 0.5 - 4.0),
            "D_skip": _w((lambda *s: torch.randn(*s, dtype=torch.bfloat16) * 0.2)(D)),
        }
    _A_in = _A_setup()

    def _B_setup():
        B, S, D, Dff = 1, 2048, 640, 1728
        return {
            "x": _w((lambda *s: torch.randn(*s, dtype=torch.bfloat16) * 0.05)(B, S, D)),
            "w1": _w((lambda *s: torch.randn(*s, dtype=torch.bfloat16) * 0.05)(D, Dff)),
            "w2": _w((lambda *s: torch.randn(*s, dtype=torch.bfloat16) * 0.05)(Dff, D)),
        }
    _B_in = _B_setup()

    return {
        "A_u": _A_in["u"],
        "A_log_A_real": _A_in["log_A_real"],
        "A_A_imag": _A_in["A_imag"],
        "A_C_real": _A_in["C_real"],
        "A_C_imag": _A_in["C_imag"],
        "A_log_dt": _A_in["log_dt"],
        "A_D_skip": _A_in["D_skip"],
        "B_x": _B_in["x"],
        "B_w1": _B_in["w1"],
        "B_w2": _B_in["w2"],
        "gate_w": _w((lambda *s: torch.randn(*s, dtype=torch.bfloat16) * 0.05)(640) * 16.0),
    }

def reference(A_u, A_log_A_real, A_A_imag, A_C_real, A_C_imag, A_log_dt, A_D_skip, B_x, B_w1, B_w2, gate_w):
    def _A_ref(u, log_A_real, A_imag, C_real, C_imag, log_dt, D_skip):
        L = u.shape[1]
        dt = torch.exp(log_dt)
        A = -torch.exp(log_A_real) + 1j * A_imag
        C = (C_real + 1j * C_imag) * dt[:, None]
        pos = (lambda x, dt: x.to(dt))(torch.arange(L), log_dt.dtype)
        P = torch.exp((A * dt[:, None])[:, :, None] * pos[None, None, :])
        K = 2.0 * torch.einsum("dn,dnl->dl", C, P).real
        L2 = 2 * L
        u_t = (lambda x, *d: x.permute(*d))(u, 0, 2, 1)
        Kf = (lambda x, *a, **k: torch.fft.rfft(x.float(), *a, **k))(K, L2)
        Uf = (lambda x, *a, **k: torch.fft.rfft(x.float(), *a, **k))(u_t, L2)
        y = (lambda x, *a, **k: torch.fft.irfft(x, *a, **k).to(torch.bfloat16))(Uf * Kf[None, :, :], L2)[:, :, :L]
        y = (lambda x, *d: x.permute(*d))(y, 0, 2, 1)
        return y + u * D_skip[None, None, :]

    def _B_ref(x, w1, w2):
        h = torch.einsum("bsd,df->bsf", x, w1)
        zero = torch.zeros_like(h)
        h = torch.maximum(h, zero)
        return torch.einsum("bsf,fd->bsd", h, w2)

    x = A_u
    g = _sigmoid((x * gate_w).sum(-1, keepdims=True))
    a = _A_ref(x, A_log_A_real, A_A_imag, A_C_real, A_C_imag, A_log_dt, A_D_skip)
    b = _B_ref(x, B_w1, B_w2)
    return g * a + (1 - g) * b
```

```asm
; @launch grid=(256,1,1) block=(512,1,1) lds=163840
.amdgcn_target "amdgcn-amd-amdhsa--gfx950"
.text
.globl gated_mix__ssm_conv_s4d__dense_activation_relu__prompt_kernel
.type gated_mix__ssm_conv_s4d__dense_activation_relu__prompt_kernel,@function
.p2align 8
gated_mix__ssm_conv_s4d__dense_activation_relu__prompt_kernel:
    s_cmp_ge_u32 s2, 256
    s_cbranch_scc1 L_end
    s_load_dwordx16 s[16:31], s[0:1], 0
    s_load_dwordx8 s[32:39], s[0:1], 64
    s_load_dwordx4 s[40:43], s[0:1], 96
    v_lshrrev_b32 v1, 6, v0
    s_getpc_b64 s[6:7]
L_pc:
    v_min_u32 v2, (L_code_end-L_pc)/128, v0
    v_lshlrev_b32 v2, 7, v2
    s_cmp_lt_u32 s2, 144
    s_cbranch_scc1 L_ncp
    global_load_dword v254, v2, s[6:7]
L_ncp:
    v_and_b32 v0, 63, v0
    v_readfirstlane_b32 s3, v1
    s_and_b32 s4, s2, 7
    s_lshr_b32 s5, s2, 3
    s_getreg_b32 s88, hwreg(HW_REG_XCC_ID, 0, 4)
    s_add_u32 s88, s88, 1
    s_mov_b32 s94, 0
    s_mov_b32 s70, 0
    s_mov_b32 s71, 0
    s_mov_b32 s76, 1
    s_mov_b32 s95, 0
    v_mov_b32 v252, 0
    v_mov_b32 v251, 0
    s_cmp_ge_u32 s5, 18
    s_cbranch_scc1 L_not_g1
    s_and_b32 s7, s5, 1
    s_lshr_b32 s6, s5, 1
    s_lshl_b32 s8, s4, 1
    s_add_u32 s7, s7, s8
    s_cmp_lt_u32 s3, 4
    s_cbranch_scc1 L_g1c
    s_setprio 2
    s_sub_u32 s9, s3, 4
    v_lshrrev_b32 v2, 3, v0
    v_mul_u32_u24 v2, 1280, v2
    v_and_b32 v3, 7, v0
    v_lshrrev_b32 v4, 4, v0
    v_xor_b32 v3, v3, v4
    v_lshl_add_u32 v10, v3, 4, v2
    v_xor_b32 v3, 4, v3
    v_lshl_add_u32 v11, v3, 4, v2
    v_add_u32 v11, 9216, v11
    v_add_u32 v12, 18432, v10
    v_add_u32 v13, 18432, v11
    v_add_u32 v2, 0, v0
    v_mul_u32_u24 v3, 2731, v2
    v_lshrrev_b32 v3, 16, v3
    v_mul_u32_u24 v4, 24, v3
    v_sub_u32 v4, v2, v4
    v_and_b32 v5, 2, v3
    v_xor_b32 v4, v4, v5
    v_mul_u32_u24 v3, 3456, v3
    v_subrev_u32 v3, 0, v3
    v_lshl_add_u32 v14, v4, 4, v3
    v_xor_b32 v4, 4, v4
    v_lshl_add_u32 v19, v4, 4, v3
    v_add_u32 v2, 64, v0
    v_mul_u32_u24 v3, 2731, v2
    v_lshrrev_b32 v3, 16, v3
    v_mul_u32_u24 v4, 24, v3
    v_sub_u32 v4, v2, v4
    v_and_b32 v5, 2, v3
    v_xor_b32 v4, v4, v5
    v_mul_u32_u24 v3, 3456, v3
    v_subrev_u32 v3, 1024, v3
    v_lshl_add_u32 v15, v4, 4, v3
    v_xor_b32 v4, 4, v4
    v_lshl_add_u32 v20, v4, 4, v3
    v_add_u32 v2, 128, v0
    v_mul_u32_u24 v3, 2731, v2
    v_lshrrev_b32 v3, 16, v3
    v_mul_u32_u24 v4, 24, v3
    v_sub_u32 v4, v2, v4
    v_and_b32 v5, 2, v3
    v_xor_b32 v4, v4, v5
    v_mul_u32_u24 v3, 3456, v3
    v_subrev_u32 v3, 2048, v3
    v_lshl_add_u32 v16, v4, 4, v3
    v_xor_b32 v4, 4, v4
    v_lshl_add_u32 v21, v4, 4, v3
    s_mul_i32 s14, s6, 0
    s_lshr_b32 s12, s4, 0
    s_mul_i32 s12, s12, 1
    s_add_u32 s14, s14, s12
    s_and_b32 s12, s7, 1
    s_mul_i32 s12, s12, 0
    s_add_u32 s14, s14, s12
    s_cmp_ge_u32 s14, 20
    s_cselect_b32 s12, 10, 0
    s_sub_u32 s14, s14, s12
    s_cmp_ge_u32 s14, 10
    s_cselect_b32 s12, 10, 0
    s_sub_u32 s14, s14, s12
    s_lshl_b32 s10, s7, 2
    s_add_u32 s10, s10, s9
    s_mul_i32 s10, s10, 40960
    s_lshl_b32 s12, s14, 7
    s_add_u32 s10, s10, s12
    s_mul_i32 s11, s9, 55296
    s_mul_i32 s12, s6, 384
    s_add_u32 s11, s11, s12
    s_mul_i32 s12, s14, 221184
    s_add_u32 s11, s11, s12
    s_lshl_b32 s12, s9, 12
    s_mul_i32 s13, s9, 6144
    s_add_u32 s13, s13, 16384
    s_mov_b32 s8, 0
    s_mov_b32 s64, 4294844416
    s_mov_b32 s65, 40960
    s_waitcnt lgkmcnt(0)
    s_mov_b32 s44, s16
    s_mov_b32 s45, s17
    s_mov_b32 s46, 0x280000
    s_mov_b32 s47, 0x00020000
    s_mov_b32 s48, s32
    s_mov_b32 s49, s33
    s_mov_b32 s50, 0x21c000
    s_mov_b32 s51, 0x00020000
    s_mov_b32 m0, s12
    s_add_u32 s15, s11, 27648
    buffer_load_dwordx4 v10, s[44:47], s10 offen lds
    buffer_load_dwordx4 v11, s[44:47], s10 offen offset:1024 lds
    buffer_load_dwordx4 v12, s[44:47], s10 offen offset:2048 lds
    buffer_load_dwordx4 v13, s[44:47], s10 offen offset:3072 lds
    s_mov_b32 m0, s13
    s_add_u32 s10, s10, 128
    buffer_load_dwordx4 v14, s[48:51], s11 offen lds
    buffer_load_dwordx4 v15, s[48:51], s11 offen offset:1024 lds
    buffer_load_dwordx4 v16, s[48:51], s11 offen offset:2048 lds
    s_add_u32 m0, s13, 3072
    s_add_u32 s11, s11, 221184
    buffer_load_dwordx4 v19, s[48:51], s15 offen lds
    buffer_load_dwordx4 v20, s[48:51], s15 offen offset:1024 lds
    buffer_load_dwordx4 v21, s[48:51], s15 offen offset:2048 lds
    s_cmp_ge_u32 s12, 122880
    s_cselect_b32 s15, s64, s65
    s_add_u32 s12, s12, s15
    s_add_u32 s13, s13, s15
    s_add_u32 s14, s14, 1
    s_cmp_eq_u32 s14, 10
    s_cselect_b32 s15, 1280, 0
    s_sub_u32 s10, s10, s15
    s_cmp_eq_u32 s14, 10
    s_cselect_b32 s15, 2211840, 0
    s_sub_u32 s11, s11, s15
    s_add_u32 s8, s8, 1
    s_mov_b32 s84, s40
    s_mov_b32 s85, s41
    s_mov_b32 s86, 0x100
    s_mov_b32 s87, 0x00020000
    s_add_u32 s96, s42, 0x990000
    s_addc_u32 s97, s43, 0
    s_mov_b32 s98, 0x2200
    s_mov_b32 s99, 0x00020000
    s_mov_b32 s56, s34
    s_mov_b32 s57, s35
    s_mov_b32 s58, 0x21c000
    s_mov_b32 s59, 0x00020000
    s_mov_b32 s52, s42
    s_mov_b32 s53, s43
    s_mov_b32 s54, 0x990000
    s_mov_b32 s55, 0x00020000
    v_lshrrev_b32 v2, 3, v0
    v_mul_u32_u24 v17, 1280, v2
    v_and_b32 v3, 7, v0
    v_and_b32 v2, 6, v2
    v_xor_b32 v3, v3, v2
    v_lshl_add_u32 v17, v3, 4, v17
    v_add_u32 v18, 9216, v17
    s_mul_i32 s68, s6, 3
    v_min_u32 v2, 26, v0
    v_add_u32 v2, s68, v2
    v_subrev_u32 v3, 27, v2
    v_min_u32 v2, v2, v3
    s_lshl_b32 s66, s7, 3
    s_lshl_b32 s67, s9, s76
    s_add_u32 s66, s66, s67
    s_mul_i32 s66, s66, 55296
    s_mul_i32 s67, s70, 3456
    s_add_u32 s66, s66, s67
    v_lshl_add_u32 v56, v2, 11, s66
    s_mul_i32 s66, s9, 20480
    s_lshl_b32 s67, s6, 7
    s_add_u32 s66, s66, s67
    v_mul_u32_u24 v2, 81920, v2
    v_add_u32 v58, s66, v2
    v_and_b32 v2, 3, v0
    v_lshlrev_b32 v2, 14, v2
    v_add_u32 v2, 114688, v2
    v_subrev_u32 v3, 163840, v2
    v_min_u32 v2, v2, v3
    s_lshl_b32 s66, s9, 11
    s_lshl_b32 s66, s66, s76
    v_add_u32 v57, s66, v2
    v_add_u32 v2, 6, v0
    v_mul_u32_u24 v3, 6554, v2
    v_lshrrev_b32 v3, 16, v3
    v_mul_u32_u24 v3, 10, v3
    v_sub_u32 v2, v2, v3
    s_lshl_b32 s66, s9, 11
    s_add_u32 s66, s66, 32768
    v_lshl_add_u32 v59, v2, 13, s66
    s_mov_b32 s73, 0
    v_readlane_b32 s66, v58, 0
    v_readlane_b32 s67, v59, 0
    s_nop 2
    s_add_u32 s74, s6, 1
    v_lshlrev_b32 v50, 4, v0
    v_add_u32 v51, 53248, v50
    v_lshrrev_b32 v2, 4, v0
    v_lshlrev_b32 v52, 12, v2
    v_and_b32 v2, 15, v0
    v_lshl_add_u32 v52, v2, 4, v52
    v_lshlrev_b32 v53, 5, v2
    v_min_u32 v248, 35, v0
    v_lshl_add_u32 v248, s74, 2, v248
    v_subrev_u32 v3, 36, v248
    v_min_u32 v248, v248, v3
    s_lshl_b32 s91, s7, 8
    v_lshl_add_u32 v248, v248, 2, s91
    s_lshl_b32 s91, s6, 8
    s_add_u32 s91, s91, 4096
    v_and_b32 v249, 7, v0
    v_lshl_add_u32 v249, v249, 2, s91
    s_mul_i32 s91, s4, 10
    s_and_b32 s92, s7, 1
    s_lshl_b32 s92, s92, 2
    s_add_u32 s91, s91, s92
    v_and_b32 v2, 3, v0
    v_add_u32 v2, s91, v2
    v_lshrrev_b32 v3, 3, v2
    v_lshlrev_b32 v3, 8, v3
    v_and_b32 v2, 7, v2
    v_lshl_add_u32 v3, v2, 2, v3
    v_add_u32 v3, 4096, v3
    v_cmp_gt_u32 vcc, 32, v0
    s_mov_b32 s69, 3
    s_mov_b32 s72, 3
    s_mov_b32 s75, 0
    v_cndmask_b32 v249, v3, v249, vcc
    v_readlane_b32 s60, v56, 3
    v_readlane_b32 s61, v57, 3
    s_nop 3
L_g1l_loop:
    s_mov_b32 m0, s12
    s_add_u32 s15, s11, 27648
    buffer_load_dwordx4 v10, s[44:47], s10 offen lds
    buffer_load_dwordx4 v11, s[44:47], s10 offen offset:1024 lds
    buffer_load_dwordx4 v12, s[44:47], s10 offen offset:2048 lds
    buffer_load_dwordx4 v13, s[44:47], s10 offen offset:3072 lds
    s_mov_b32 m0, s13
    s_add_u32 s10, s10, 128
    buffer_load_dwordx4 v14, s[48:51], s11 offen lds
    buffer_load_dwordx4 v15, s[48:51], s11 offen offset:1024 lds
    buffer_load_dwordx4 v16, s[48:51], s11 offen offset:2048 lds
    s_add_u32 m0, s13, 3072
    s_add_u32 s11, s11, 221184
    buffer_load_dwordx4 v19, s[48:51], s15 offen lds
    buffer_load_dwordx4 v20, s[48:51], s15 offen offset:1024 lds
    buffer_load_dwordx4 v21, s[48:51], s15 offen offset:2048 lds
    s_cmp_ge_u32 s12, 122880
    s_cselect_b32 s15, s64, s65
    s_add_u32 s12, s12, s15
    s_add_u32 s13, s13, s15
    s_add_u32 s14, s14, 1
    s_cmp_eq_u32 s14, 10
    s_cselect_b32 s15, 1280, 0
    s_sub_u32 s10, s10, s15
    s_cmp_eq_u32 s14, 10
    s_cselect_b32 s15, 2211840, 0
    s_sub_u32 s11, s11, s15
    s_add_u32 s8, s8, 1
L_g1l_wt:
    s_waitcnt vmcnt(10)
    s_barrier
    s_cmp_lt_u32 s8, 10
    s_cbranch_scc1 L_g1l_loop
L_wp0:
    s_mov_b32 m0, s67
    s_add_u32 s73, s73, 1
    buffer_load_dwordx4 v17, s[56:59], s66 offen lds
    buffer_load_dwordx4 v18, s[56:59], s66 offen offset:1024 lds
    v_readlane_b32 s66, v58, s73
    v_readlane_b32 s67, v59, s73
    s_cmp_lt_u32 s73, 4
    s_cbranch_scc1 L_wp0
    s_nop 1
    s_waitcnt vmcnt(8)
    s_barrier
    s_add_u32 s73, s73, 1
    buffer_load_dwordx4 v[64:67], v17, s[56:59], s66 offen
    buffer_load_dwordx4 v[68:71], v18, s[56:59], s66 offen offset:1024
    v_readlane_b32 s66, v58, s73
    v_readlane_b32 s67, v59, s73
    s_nop 2
    s_add_u32 s73, s73, 1
    buffer_load_dwordx4 v[72:75], v17, s[56:59], s66 offen
    buffer_load_dwordx4 v[76:79], v18, s[56:59], s66 offen offset:1024
    v_readlane_b32 s66, v58, s73
    v_readlane_b32 s67, v59, s73
    s_nop 2
    s_add_u32 s73, s73, 1
    buffer_load_dwordx4 v[80:83], v17, s[56:59], s66 offen
    buffer_load_dwordx4 v[84:87], v18, s[56:59], s66 offen offset:1024
    v_readlane_b32 s66, v58, s73
    v_readlane_b32 s67, v59, s73
    s_nop 2
    s_add_u32 s73, s73, 1
    buffer_load_dwordx4 v[88:91], v17, s[56:59], s66 offen
    buffer_load_dwordx4 v[92:95], v18, s[56:59], s66 offen offset:1024
    v_readlane_b32 s66, v58, s73
    v_readlane_b32 s67, v59, s73
    s_nop 2
    s_add_u32 s73, s73, 1
    buffer_load_dwordx4 v[96:99], v17, s[56:59], s66 offen
    buffer_load_dwordx4 v[100:103], v18, s[56:59], s66 offen offset:1024
    v_readlane_b32 s66, v58, s73
    v_readlane_b32 s67, v59, s73
    s_nop 2
    s_add_u32 s73, s73, 1
    buffer_load_dwordx4 v[104:107], v17, s[56:59], s66 offen
    buffer_load_dwordx4 v[108:111], v18, s[56:59], s66 offen offset:1024
    v_readlane_b32 s66, v58, s73
    v_readlane_b32 s67, v59, s73
    s_nop 2
    s_lshl_b32 s15, s9, 11
    s_add_u32 s15, s15, 32768
    v_add_u32 v54, s15, v50
    s_barrier
    s_waitcnt vmcnt(10)
    ds_write_b128 v54, v[64:67] offset:0
    ds_write_b128 v54, v[68:71] offset:1024
    s_waitcnt vmcnt(8)
    ds_write_b128 v54, v[72:75] offset:8192
    ds_write_b128 v54, v[76:79] offset:9216
    s_waitcnt vmcnt(6)
    ds_write_b128 v54, v[80:83] offset:16384
    ds_write_b128 v54, v[84:87] offset:17408
    s_waitcnt vmcnt(4)
    ds_write_b128 v54, v[88:91] offset:24576
    ds_write_b128 v54, v[92:95] offset:25600
    s_waitcnt vmcnt(2)
    ds_write_b128 v54, v[96:99] offset:32768
    ds_write_b128 v54, v[100:103] offset:33792
    s_waitcnt vmcnt(0)
    ds_write_b128 v54, v[104:107] offset:40960
    ds_write_b128 v54, v[108:111] offset:41984
    s_waitcnt lgkmcnt(0)
    s_barrier
    s_cmp_lt_u32 s69, s75
    s_cbranch_scc1 L_hk0
    s_getpc_b64 s[78:79]
    s_branch L_hpoll
L_hk0:
    s_mov_b32 m0, s61
    s_add_u32 s69, s69, 1
    buffer_load_dwordx4 v50, s[52:55], s60 offen sc1 lds
    buffer_load_dwordx4 v50, s[52:55], s60 offen offset:1024 sc1 lds
    buffer_load_dwordx4 v51, s[52:55], s60 offen offset:2048 sc1 lds
    buffer_load_dwordx4 v51, s[52:55], s60 offen offset:3072 sc1 lds
    v_readlane_b32 s60, v56, s69
    v_readlane_b32 s61, v57, s69
    s_barrier
    s_branch L_g2l_pre
L_g1c:
    s_lshr_b32 s8, s3, 1
    s_and_b32 s9, s3, 1
    v_and_b32 v14, 15, v0
    s_lshl_b32 s10, s8, 6
    v_add_u32 v15, s10, v14
    v_lshlrev_b32 v15, 7, v15
    v_bfe_u32 v14, v0, 1, 3
    v_lshrrev_b32 v1, 4, v0
    v_xor_b32 v14, v14, v1
    v_lshl_add_u32 v2, v14, 4, v15
    v_xor_b32 v14, 4, v14
    v_lshl_add_u32 v3, v14, 4, v15
    v_lshlrev_b32 v1, 3, v1
    v_bfe_u32 v14, v0, 2, 2
    v_add_u32 v1, v1, v14
    v_mul_u32_u24 v1, 384, v1
    v_and_b32 v14, 3, v0
    v_lshl_add_u32 v1, v14, 3, v1
    v_add_u32 v1, 16384, v1
    v_bfe_u32 v14, v0, 3, 2
    s_mul_i32 s10, s9, 6
    s_add_u32 s11, s10, 0
    v_xor_b32 v15, s11, v14
    v_lshl_add_u32 v4, v15, 5, v1
    s_add_u32 s11, s10, 1
    v_xor_b32 v15, s11, v14
    v_lshl_add_u32 v5, v15, 5, v1
    s_add_u32 s11, s10, 2
    v_xor_b32 v15, s11, v14
    v_lshl_add_u32 v6, v15, 5, v1
    s_add_u32 s11, s10, 3
    v_xor_b32 v15, s11, v14
    v_lshl_add_u32 v7, v15, 5, v1
    v_mov_b32 v16, 0
    v_mov_b32 v17, 0
    v_mov_b32 v18, 0
    v_mov_b32 v19, 0
    v_mov_b32 v20, 0
    v_mov_b32 v21, 0
    v_mov_b32 v22, 0
    v_mov_b32 v23, 0
    v_mov_b32 v24, 0
    v_mov_b32 v25, 0
    v_mov_b32 v26, 0
    v_mov_b32 v27, 0
    v_mov_b32 v28, 0
    v_mov_b32 v29, 0
    v_mov_b32 v30, 0
    v_mov_b32 v31, 0
    v_mov_b32 v32, 0
    v_mov_b32 v33, 0
    v_mov_b32 v34, 0
    v_mov_b32 v35, 0
    v_mov_b32 v36, 0
    v_mov_b32 v37, 0
    v_mov_b32 v38, 0
    v_mov_b32 v39, 0
    v_mov_b32 v40, 0
    v_mov_b32 v41, 0
    v_mov_b32 v42, 0
    v_mov_b32 v43, 0
    v_mov_b32 v44, 0
    v_mov_b32 v45, 0
    v_mov_b32 v46, 0
    v_mov_b32 v47, 0
    v_mov_b32 v48, 0
    v_mov_b32 v49, 0
    v_mov_b32 v50, 0
    v_mov_b32 v51, 0
    v_mov_b32 v52, 0
    v_mov_b32 v53, 0
    v_mov_b32 v54, 0
    v_mov_b32 v55, 0
    v_mov_b32 v56, 0
    v_mov_b32 v57, 0
    v_mov_b32 v58, 0
    v_mov_b32 v59, 0
    v_mov_b32 v60, 0
    v_mov_b32 v61, 0
    v_mov_b32 v62, 0
    v_mov_b32 v63, 0
    v_mov_b32 v64, 0
    v_mov_b32 v65, 0
    v_mov_b32 v66, 0
    v_mov_b32 v67, 0
    v_mov_b32 v68, 0
    v_mov_b32 v69, 0
    v_mov_b32 v70, 0
    v_mov_b32 v71, 0
    v_mov_b32 v72, 0
    v_mov_b32 v73, 0
    v_mov_b32 v74, 0
    v_mov_b32 v75, 0
    v_mov_b32 v76, 0
    v_mov_b32 v77, 0
    v_mov_b32 v78, 0
    v_mov_b32 v79, 0
    v_mov_b32 v80, 0
    v_mov_b32 v81, 0
    v_mov_b32 v82, 0
    v_mov_b32 v83, 0
    v_mov_b32 v84, 0
    v_mov_b32 v85, 0
    v_mov_b32 v86, 0
    v_mov_b32 v87, 0
    v_mov_b32 v88, 0
    v_mov_b32 v89, 0
    v_mov_b32 v90, 0
    v_mov_b32 v91, 0
    v_mov_b32 v92, 0
    v_mov_b32 v93, 0
    v_mov_b32 v94, 0
    v_mov_b32 v95, 0
    v_mov_b32 v96, 0
    v_mov_b32 v97, 0
    v_mov_b32 v98, 0
    v_mov_b32 v99, 0
    v_mov_b32 v100, 0
    v_mov_b32 v101, 0
    v_mov_b32 v102, 0
    v_mov_b32 v103, 0
    v_mov_b32 v104, 0
    v_mov_b32 v105, 0
    v_mov_b32 v106, 0
    v_mov_b32 v107, 0
    v_mov_b32 v108, 0
    v_mov_b32 v109, 0
    v_mov_b32 v110, 0
    v_mov_b32 v111, 0
    v_lshlrev_b32 v1, 4, v0
    s_lshl_b32 s66, s7, 1
    s_add_u32 s66, s66, s8
    s_mul_i32 s66, s66, 216
    s_mul_i32 s11, s6, 6
    s_mul_i32 s12, s9, 3
    s_add_u32 s11, s11, s12
    s_add_u32 s66, s66, s11
    s_lshl_b32 s66, s66, 10
    s_add_u32 s67, s66, 55296
    s_add_u32 s68, s66, 110592
    s_add_u32 s69, s66, 165888
    s_lshl_b32 s12, s8, 13
    s_add_u32 s12, s12, 114688
    s_mul_i32 s13, s9, 31744
    s_add_u32 s13, s13, s12
    v_add_u32 v241, s13, v1
    s_mul_i32 s13, s9, 17408
    s_add_u32 s13, s13, s12
    v_add_u32 v240, s13, v1
    s_waitcnt lgkmcnt(0)
    s_mov_b32 s52, s42
    s_mov_b32 s53, s43
    s_mov_b32 s54, 0x6c0000
    s_mov_b32 s55, 0x00020000
    s_mov_b32 s84, s40
    s_mov_b32 s85, s41
    s_mov_b32 s86, 0x100
    s_mov_b32 s87, 0x00020000
    s_add_u32 s96, s42, 0x990000
    s_addc_u32 s97, s43, 0
    s_mov_b32 s98, 0x2200
    s_mov_b32 s99, 0x00020000
    s_mov_b32 s60, s38
    s_mov_b32 s61, s39
    s_mov_b32 s62, 0x280000
    s_mov_b32 s63, 0x00020000
    v_and_b32 v230, 15, v0
    v_lshrrev_b32 v231, 4, v0
    s_lshl_b32 s58, s8, s76
    s_lshl_b32 s56, s58, 12
    v_lshl_add_u32 v224, v0, 4, s56
    v_lshrrev_b32 v232, 2, v0
    v_lshlrev_b32 v233, 7, v232
    v_and_b32 v232, 3, v0
    v_lshl_add_u32 v233, v232, 3, v233
    v_add_u32 v233, 32768, v233
    v_bfe_u32 v232, v0, 3, 2
    s_lshl_b32 s56, s9, 1
    v_xor_b32 v232, s56, v232
    v_lshl_add_u32 v225, v232, 5, v233
    v_xor_b32 v232, 1, v232
    v_lshl_add_u32 v226, v232, 5, v233
    v_lshrrev_b32 v232, 2, v0
    v_lshlrev_b32 v227, 8, v232
    v_and_b32 v232, 3, v0
    v_lshl_add_u32 v227, v232, 3, v227
    s_lshl_b32 s56, s9, 13
    s_lshl_b32 s57, s58, 6
    s_add_u32 s56, s56, s57
    s_add_u32 s56, s56, 16384
    v_add_u32 v227, s56, v227
    v_bfe_u32 v232, v0, 2, 3
    v_lshlrev_b32 v232, 5, v232
    v_xor_b32 v227, v227, v232
    v_lshl_add_u32 v229, v230, 1, s57
    v_mul_u32_u24 v228, 1280, v230
    v_and_b32 v232, 1, v231
    v_lshl_add_u32 v228, v232, 5, v228
    v_lshrrev_b32 v232, 1, v231
    v_lshl_add_u32 v228, v232, 4, v228
    s_lshl_b32 s56, s7, 2
    s_add_u32 s56, s56, s58
    s_mul_i32 s65, s56, 40960
    s_lshl_b32 s56, s6, 7
    s_add_u32 s65, s65, s56
    s_lshl_b32 s56, s9, 6
    s_add_u32 s65, s65, s56
    s_mul_i32 s56, s70, 1280
    s_add_u32 s65, s65, s56
    s_mov_b32 s64, 0xffff0000
    v_mov_b32 v192, 0
    v_mov_b32 v193, 0
    v_mov_b32 v194, 0
    v_mov_b32 v195, 0
    v_mov_b32 v196, 0
    v_mov_b32 v197, 0
    v_mov_b32 v198, 0
    v_mov_b32 v199, 0
    v_mov_b32 v200, 0
    v_mov_b32 v201, 0
    v_mov_b32 v202, 0
    v_mov_b32 v203, 0
    v_mov_b32 v204, 0
    v_mov_b32 v205, 0
    v_mov_b32 v206, 0
    v_mov_b32 v207, 0
    v_mov_b32 v208, 0
    v_mov_b32 v209, 0
    v_mov_b32 v210, 0
    v_mov_b32 v211, 0
    v_mov_b32 v212, 0
    v_mov_b32 v213, 0
    v_mov_b32 v214, 0
    v_mov_b32 v215, 0
    v_mov_b32 v216, 0
    v_mov_b32 v217, 0
    v_mov_b32 v218, 0
    v_mov_b32 v219, 0
    v_mov_b32 v220, 0
    v_mov_b32 v221, 0
    v_mov_b32 v222, 0
    v_mov_b32 v223, 0
    v_mov_b32 v234, 0
    v_mov_b32 v235, 0
    v_mov_b32 v236, 0
    v_mov_b32 v237, 0
    v_mov_b32 v245, 0
    s_cmp_eq_u32 s3, 0
    s_cselect_b32 s15, 1, 7
    s_mov_b32 s12, 0
    s_mov_b32 s13, 0
    s_mov_b32 s14, 0
    v_mov_b32 v8, v2
    v_mov_b32 v9, v3
    v_mov_b32 v10, v4
    v_mov_b32 v11, v5
    v_mov_b32 v12, v6
    v_mov_b32 v13, v7
    s_barrier
    ds_read_b64_tr_b16 v[112:113], v10 offset:0
    ds_read_b64_tr_b16 v[114:115], v10 offset:1536
    ds_read_b128 v[136:139], v8 offset:0
    ds_read_b128 v[140:143], v8 offset:2048
    ds_read_b128 v[144:147], v8 offset:4096
    ds_read_b128 v[148:151], v8 offset:6144
    ds_read_b64_tr_b16 v[116:117], v11 offset:0
    ds_read_b64_tr_b16 v[118:119], v11 offset:1536
    ds_read_b64_tr_b16 v[120:121], v12 offset:0
    ds_read_b64_tr_b16 v[122:123], v12 offset:1536
    ds_read_b64_tr_b16 v[124:125], v13 offset:0
    ds_read_b64_tr_b16 v[126:127], v13 offset:1536
    ds_read_b64_tr_b16 v[128:129], v10 offset:128
    ds_read_b64_tr_b16 v[130:131], v10 offset:1664
    ds_read_b64_tr_b16 v[132:133], v11 offset:128
    ds_read_b64_tr_b16 v[134:135], v11 offset:1664
    s_waitcnt lgkmcnt(0)
    s_branch L_g1c_mid
L_g1c_hook:
    s_cmp_eq_u32 s15, 1
    s_cbranch_scc0 L_g1c_hk2
    buffer_load_dword v251, v252, s[84:87], 0 offen sc1
    s_mov_b32 s15, 3
    s_branch L_g1c_loop
L_g1c_hk2:
    s_cmp_eq_u32 s15, 3
    s_cbranch_scc1 L_g1c_hk3
    s_lshl_b32 s90, s4, 8
    s_add_u32 s90, s90, 6656
    v_min_u32 v246, 21, v0
    v_lshlrev_b32 v246, 2, v246
    buffer_load_dword v245, v246, s[96:99], s90 offen sc1
    s_mov_b32 s15, 10
    s_branch L_g1c_loop
L_g1c_hk3:
L_join0:
    s_waitcnt vmcnt(0)
    v_readfirstlane_b32 s90, v251
    s_lshl_b32 s91, s4, 6
    s_add_u32 s91, s91, s5
    s_lshl_b32 s91, s91, 2
    s_add_u32 s91, s91, 6656
    s_cmp_eq_u32 s90, 1
    s_cbranch_scc1 L_joined0
    s_sleep 4
    buffer_load_dword v251, v252, s[84:87], 0 offen sc1
    s_add_u32 s94, s94, 1
    s_cmp_lt_u32 s94, 0x100000
    s_cbranch_scc1 L_join0
L_joined0:
    v_mov_b32 v253, s88
    s_mov_b64 exec, 1
    buffer_store_dword v253, v252, s[96:99], s91 offen sc1
    s_mov_b64 exec, -1
    s_mov_b32 s15, 7
    s_nop 2
.p2align 3
L_g1c_loop:
    v_mfma_f32_16x16x32_bf16 v[16:19], v[152:155], v[176:179], v[16:19]
    v_mfma_f32_16x16x32_bf16 v[24:27], v[152:155], v[180:183], v[24:27]
    s_barrier
    s_nop 0
    v_mfma_f32_16x16x32_bf16 v[32:35], v[152:155], v[184:187], v[32:35]
    ds_read_b64_tr_b16 v[112:113], v10 offset:0
    v_mfma_f32_16x16x32_bf16 v[40:43], v[152:155], v[188:191], v[40:43]
    ds_read_b64_tr_b16 v[114:115], v10 offset:1536
    v_mfma_f32_16x16x32_bf16 v[20:23], v[156:159], v[176:179], v[20:23]
    ds_read_b128 v[136:139], v8 offset:0
    v_mfma_f32_16x16x32_bf16 v[28:31], v[156:159], v[180:183], v[28:31]
    ds_read_b128 v[140:143], v8 offset:2048
    v_mfma_f32_16x16x32_bf16 v[36:39], v[156:159], v[184:187], v[36:39]
    ds_read_b128 v[144:147], v8 offset:4096
    v_mfma_f32_16x16x32_bf16 v[44:47], v[156:159], v[188:191], v[44:47]
    ds_read_b128 v[148:151], v8 offset:6144
    v_mfma_f32_16x16x32_bf16 v[48:51], v[160:163], v[176:179], v[48:51]
    ds_read_b64_tr_b16 v[116:117], v11 offset:0
    v_mfma_f32_16x16x32_bf16 v[56:59], v[160:163], v[180:183], v[56:59]
    ds_read_b64_tr_b16 v[118:119], v11 offset:1536
    v_mfma_f32_16x16x32_bf16 v[64:67], v[160:163], v[184:187], v[64:67]
    ds_read_b64_tr_b16 v[120:121], v12 offset:0
    v_mfma_f32_16x16x32_bf16 v[72:75], v[160:163], v[188:191], v[72:75]
    ds_read_b64_tr_b16 v[122:123], v12 offset:1536
    v_mfma_f32_16x16x32_bf16 v[52:55], v[164:167], v[176:179], v[52:55]
    ds_read_b64_tr_b16 v[124:125], v13 offset:0
    v_mfma_f32_16x16x32_bf16 v[60:63], v[164:167], v[180:183], v[60:63]
    ds_read_b64_tr_b16 v[126:127], v13 offset:1536
    v_mfma_f32_16x16x32_bf16 v[68:71], v[164:167], v[184:187], v[68:71]
    ds_read_b64_tr_b16 v[128:129], v10 offset:128
    v_mfma_f32_16x16x32_bf16 v[76:79], v[164:167], v[188:191], v[76:79]
    ds_read_b64_tr_b16 v[130:131], v10 offset:1664
    v_mfma_f32_16x16x32_bf16 v[80:83], v[168:171], v[176:179], v[80:83]
    ds_read_b64_tr_b16 v[132:133], v11 offset:128
    v_mfma_f32_16x16x32_bf16 v[88:91], v[168:171], v[180:183], v[88:91]
    ds_read_b64_tr_b16 v[134:135], v11 offset:1664
    v_mfma_f32_16x16x32_bf16 v[96:99], v[168:171], v[184:187], v[96:99]
    v_mfma_f32_16x16x32_bf16 v[104:107], v[168:171], v[188:191], v[104:107]
    v_mfma_f32_16x16x32_bf16 v[84:87], v[172:175], v[176:179], v[84:87]
    v_mfma_f32_16x16x32_bf16 v[92:95], v[172:175], v[180:183], v[92:95]
    v_mfma_f32_16x16x32_bf16 v[100:103], v[172:175], v[184:187], v[100:103]
    v_mfma_f32_16x16x32_bf16 v[108:111], v[172:175], v[188:191], v[108:111]
    s_waitcnt lgkmcnt(0)
    s_nop 0
L_g1c_mid:
    v_mfma_f32_16x16x32_bf16 v[16:19], v[112:115], v[136:139], v[16:19]
    ds_read_b64_tr_b16 v[152:153], v10 offset:12288
    v_mfma_f32_16x16x32_bf16 v[24:27], v[112:115], v[140:143], v[24:27]
    ds_read_b64_tr_b16 v[154:155], v10 offset:13824
    v_mfma_f32_16x16x32_bf16 v[32:35], v[112:115], v[144:147], v[32:35]
    ds_read_b128 v[176:179], v9 offset:0
    v_mfma_f32_16x16x32_bf16 v[40:43], v[112:115], v[148:151], v[40:43]
    ds_read_b128 v[180:183], v9 offset:2048
    v_mfma_f32_16x16x32_bf16 v[20:23], v[116:119], v[136:139], v[20:23]
    ds_read_b128 v[184:187], v9 offset:4096
    v_mfma_f32_16x16x32_bf16 v[28:31], v[116:119], v[140:143], v[28:31]
    ds_read_b128 v[188:191], v9 offset:6144
    v_mfma_f32_16x16x32_bf16 v[36:39], v[116:119], v[144:147], v[36:39]
    ds_read_b64_tr_b16 v[156:157], v11 offset:12288
    v_mfma_f32_16x16x32_bf16 v[44:47], v[116:119], v[148:151], v[44:47]
    ds_read_b64_tr_b16 v[158:159], v11 offset:13824
    v_mfma_f32_16x16x32_bf16 v[48:51], v[120:123], v[136:139], v[48:51]
    ds_read_b64_tr_b16 v[160:161], v12 offset:12288
    v_mfma_f32_16x16x32_bf16 v[56:59], v[120:123], v[140:143], v[56:59]
    ds_read_b64_tr_b16 v[162:163], v12 offset:13824
    v_mfma_f32_16x16x32_bf16 v[64:67], v[120:123], v[144:147], v[64:67]
    ds_read_b64_tr_b16 v[164:165], v13 offset:12288
    v_mfma_f32_16x16x32_bf16 v[72:75], v[120:123], v[148:151], v[72:75]
    ds_read_b64_tr_b16 v[166:167], v13 offset:13824
    v_mfma_f32_16x16x32_bf16 v[52:55], v[124:127], v[136:139], v[52:55]
    ds_read_b64_tr_b16 v[168:169], v10 offset:12416
    v_mfma_f32_16x16x32_bf16 v[60:63], v[124:127], v[140:143], v[60:63]
    ds_read_b64_tr_b16 v[170:171], v10 offset:13952
    v_mfma_f32_16x16x32_bf16 v[68:71], v[124:127], v[144:147], v[68:71]
    ds_read_b64_tr_b16 v[172:173], v11 offset:12416
    v_mfma_f32_16x16x32_bf16 v[76:79], v[124:127], v[148:151], v[76:79]
    ds_read_b64_tr_b16 v[174:175], v11 offset:13952
    v_mfma_f32_16x16x32_bf16 v[80:83], v[128:131], v[136:139], v[80:83]
    s_add_u32 s12, s12, 40960
    s_cmp_ge_u32 s12, 163840
    v_mfma_f32_16x16x32_bf16 v[88:91], v[128:131], v[140:143], v[88:91]
    s_cselect_b32 s12, 0, s12
    s_add_u32 s14, s14, 1
    v_mfma_f32_16x16x32_bf16 v[96:99], v[128:131], v[144:147], v[96:99]
    v_add_u32 v8, s12, v2
    v_add_u32 v9, s12, v3
    v_mfma_f32_16x16x32_bf16 v[104:107], v[128:131], v[148:151], v[104:107]
    v_add_u32 v10, s12, v4
    v_add_u32 v11, s12, v5
    v_mfma_f32_16x16x32_bf16 v[84:87], v[132:135], v[136:139], v[84:87]
    v_add_u32 v12, s12, v6
    v_add_u32 v13, s12, v7
    v_mfma_f32_16x16x32_bf16 v[92:95], v[132:135], v[140:143], v[92:95]
    s_cmp_lg_u32 s14, s15
    s_nop 0
    v_mfma_f32_16x16x32_bf16 v[100:103], v[132:135], v[144:147], v[100:103]
    v_mfma_f32_16x16x32_bf16 v[108:111], v[132:135], v[148:151], v[108:111]
    s_waitcnt lgkmcnt(0)
    s_cbranch_scc1 L_g1c_loop
    s_cmp_lt_u32 s14, 10
    s_cbranch_scc1 L_g1c_hook
    v_mfma_f32_16x16x32_bf16 v[16:19], v[152:155], v[176:179], v[16:19]
    v_mfma_f32_16x16x32_bf16 v[20:23], v[156:159], v[176:179], v[20:23]
    v_mfma_f32_16x16x32_bf16 v[24:27], v[152:155], v[180:183], v[24:27]
    v_mfma_f32_16x16x32_bf16 v[28:31], v[156:159], v[180:183], v[28:31]
    v_mfma_f32_16x16x32_bf16 v[32:35], v[152:155], v[184:187], v[32:35]
    v_mfma_f32_16x16x32_bf16 v[36:39], v[156:159], v[184:187], v[36:39]
    v_mfma_f32_16x16x32_bf16 v[40:43], v[152:155], v[188:191], v[40:43]
    v_mfma_f32_16x16x32_bf16 v[44:47], v[156:159], v[188:191], v[44:47]
    v_mfma_f32_16x16x32_bf16 v[48:51], v[160:163], v[176:179], v[48:51]
    v_mfma_f32_16x16x32_bf16 v[52:55], v[164:167], v[176:179], v[52:55]
    v_cvt_pk_bf16_f32 v16, v16, v17
    v_cvt_pk_bf16_f32 v17, v18, v19
    v_cvt_pk_bf16_f32 v18, v20, v21
    v_cvt_pk_bf16_f32 v19, v22, v23
    v_mfma_f32_16x16x32_bf16 v[56:59], v[160:163], v[180:183], v[56:59]
    v_pk_max_i16 v16, v16, 0
    v_pk_max_i16 v17, v17, 0
    v_pk_max_i16 v18, v18, 0
    v_pk_max_i16 v19, v19, 0
    v_mfma_f32_16x16x32_bf16 v[60:63], v[164:167], v[180:183], v[60:63]
    buffer_store_dwordx4 v[16:19], v1, s[52:55], s66 offen offset:0 sc1
    v_cvt_pk_bf16_f32 v24, v24, v25
    v_cvt_pk_bf16_f32 v25, v26, v27
    v_cvt_pk_bf16_f32 v26, v28, v29
    v_cvt_pk_bf16_f32 v27, v30, v31
    v_mfma_f32_16x16x32_bf16 v[64:67], v[160:163], v[184:187], v[64:67]
    v_pk_max_i16 v24, v24, 0
    v_pk_max_i16 v25, v25, 0
    v_pk_max_i16 v26, v26, 0
    v_pk_max_i16 v27, v27, 0
    v_mfma_f32_16x16x32_bf16 v[68:71], v[164:167], v[184:187], v[68:71]
    buffer_store_dwordx4 v[24:27], v1, s[52:55], s67 offen offset:0 sc1
    v_cvt_pk_bf16_f32 v32, v32, v33
    v_cvt_pk_bf16_f32 v33, v34, v35
    v_cvt_pk_bf16_f32 v34, v36, v37
    v_cvt_pk_bf16_f32 v35, v38, v39
    v_mfma_f32_16x16x32_bf16 v[72:75], v[160:163], v[188:191], v[72:75]
    v_pk_max_i16 v32, v32, 0
    v_pk_max_i16 v33, v33, 0
    v_pk_max_i16 v34, v34, 0
    v_pk_max_i16 v35, v35, 0
    v_mfma_f32_16x16x32_bf16 v[76:79], v[164:167], v[188:191], v[76:79]
    buffer_store_dwordx4 v[32:35], v1, s[52:55], s68 offen offset:0 sc1
    v_cvt_pk_bf16_f32 v40, v40, v41
    v_cvt_pk_bf16_f32 v41, v42, v43
    v_cvt_pk_bf16_f32 v42, v44, v45
    v_cvt_pk_bf16_f32 v43, v46, v47
    v_mfma_f32_16x16x32_bf16 v[80:83], v[168:171], v[176:179], v[80:83]
    v_pk_max_i16 v40, v40, 0
    v_pk_max_i16 v41, v41, 0
    v_pk_max_i16 v42, v42, 0
    v_pk_max_i16 v43, v43, 0
    v_mfma_f32_16x16x32_bf16 v[84:87], v[172:175], v[176:179], v[84:87]
    buffer_store_dwordx4 v[40:43], v1, s[52:55], s69 offen offset:0 sc1
    v_cvt_pk_bf16_f32 v48, v48, v49
    v_cvt_pk_bf16_f32 v49, v50, v51
    v_cvt_pk_bf16_f32 v50, v52, v53
    v_cvt_pk_bf16_f32 v51, v54, v55
    v_mfma_f32_16x16x32_bf16 v[88:91], v[168:171], v[180:183], v[88:91]
    v_pk_max_i16 v48, v48, 0
    v_pk_max_i16 v49, v49, 0
    v_pk_max_i16 v50, v50, 0
    v_pk_max_i16 v51, v51, 0
    v_mfma_f32_16x16x32_bf16 v[92:95], v[172:175], v[180:183], v[92:95]
    buffer_store_dwordx4 v[48:51], v1, s[52:55], s66 offen offset:1024 sc1
    v_cvt_pk_bf16_f32 v56, v56, v57
    v_cvt_pk_bf16_f32 v57, v58, v59
    v_cvt_pk_bf16_f32 v58, v60, v61
    v_cvt_pk_bf16_f32 v59, v62, v63
    v_mfma_f32_16x16x32_bf16 v[96:99], v[168:171], v[184:187], v[96:99]
    v_pk_max_i16 v56, v56, 0
    v_pk_max_i16 v57, v57, 0
    v_pk_max_i16 v58, v58, 0
    v_pk_max_i16 v59, v59, 0
    v_mfma_f32_16x16x32_bf16 v[100:103], v[172:175], v[184:187], v[100:103]
    buffer_store_dwordx4 v[56:59], v1, s[52:55], s67 offen offset:1024 sc1
    v_cvt_pk_bf16_f32 v64, v64, v65
    v_cvt_pk_bf16_f32 v65, v66, v67
    v_cvt_pk_bf16_f32 v66, v68, v69
    v_cvt_pk_bf16_f32 v67, v70, v71
    v_mfma_f32_16x16x32_bf16 v[104:107], v[168:171], v[188:191], v[104:107]
    v_pk_max_i16 v64, v64, 0
    v_pk_max_i16 v65, v65, 0
    v_pk_max_i16 v66, v66, 0
    v_pk_max_i16 v67, v67, 0
    v_mfma_f32_16x16x32_bf16 v[108:111], v[172:175], v[188:191], v[108:111]
    buffer_store_dwordx4 v[64:67], v1, s[52:55], s68 offen offset:1024 sc1
    s_barrier
    v_cvt_pk_bf16_f32 v72, v72, v73
    v_cvt_pk_bf16_f32 v73, v74, v75
    v_cvt_pk_bf16_f32 v74, v76, v77
    v_cvt_pk_bf16_f32 v75, v78, v79
    v_pk_max_i16 v72, v72, 0
    v_pk_max_i16 v73, v73, 0
    v_pk_max_i16 v74, v74, 0
    v_pk_max_i16 v75, v75, 0
    buffer_store_dwordx4 v[72:75], v1, s[52:55], s69 offen offset:1024 sc1
    v_cvt_pk_bf16_f32 v80, v80, v81
    v_cvt_pk_bf16_f32 v81, v82, v83
    v_cvt_pk_bf16_f32 v82, v84, v85
    v_cvt_pk_bf16_f32 v83, v86, v87
    v_pk_max_i16 v80, v80, 0
    v_pk_max_i16 v81, v81, 0
    v_pk_max_i16 v82, v82, 0
    v_pk_max_i16 v83, v83, 0
    buffer_store_dwordx4 v[80:83], v1, s[52:55], s66 offen offset:2048 sc1
    v_cvt_pk_bf16_f32 v88, v88, v89
    v_cvt_pk_bf16_f32 v89, v90, v91
    v_cvt_pk_bf16_f32 v90, v92, v93
    v_cvt_pk_bf16_f32 v91, v94, v95
    v_pk_max_i16 v88, v88, 0
    v_pk_max_i16 v89, v89, 0
    v_pk_max_i16 v90, v90, 0
    v_pk_max_i16 v91, v91, 0
    buffer_store_dwordx4 v[88:91], v1, s[52:55], s67 offen offset:2048 sc1
    v_cvt_pk_bf16_f32 v96, v96, v97
    v_cvt_pk_bf16_f32 v97, v98, v99
    v_cvt_pk_bf16_f32 v98, v100, v101
    v_cvt_pk_bf16_f32 v99, v102, v103
    v_pk_max_i16 v96, v96, 0
    v_pk_max_i16 v97, v97, 0
    v_pk_max_i16 v98, v98, 0
    v_pk_max_i16 v99, v99, 0
    buffer_store_dwordx4 v[96:99], v1, s[52:55], s68 offen offset:2048 sc1
    v_cvt_pk_bf16_f32 v104, v104, v105
    v_cvt_pk_bf16_f32 v105, v106, v107
    v_cvt_pk_bf16_f32 v106, v108, v109
    v_cvt_pk_bf16_f32 v107, v110, v111
    v_pk_max_i16 v104, v104, 0
    v_pk_max_i16 v105, v105, 0
    v_pk_max_i16 v106, v106, 0
    v_pk_max_i16 v107, v107, 0
    buffer_store_dwordx4 v[104:107], v1, s[52:55], s69 offen offset:2048 sc1
    ds_write_b128 v240, v[16:19] offset:0
    ds_write_b128 v240, v[24:27] offset:2048
    ds_write_b128 v240, v[32:35] offset:4096
    ds_write_b128 v240, v[40:43] offset:6144
    ds_write_b128 v241, v[48:51] offset:1024
    ds_write_b128 v241, v[56:59] offset:3072
    ds_write_b128 v241, v[64:67] offset:5120
    ds_write_b128 v241, v[72:75] offset:7168
    ds_write_b128 v240, v[80:83] offset:16384
    ds_write_b128 v240, v[88:91] offset:18432
    ds_write_b128 v240, v[96:99] offset:20480
    ds_write_b128 v240, v[104:107] offset:22528
    s_lshl_b32 s89, s7, 4
    s_add_u32 s89, s89, s6
    s_lshl_b32 s89, s89, 2
    s_add_u32 s89, s89, s3
    s_lshl_b32 s89, s89, 2
    s_mov_b32 s12, 114688
    s_mov_b32 s13, 49152
    s_mov_b32 s15, 0
    v_add_u32 v6, s12, v224
    v_add_u32 v7, s13, v225
    v_add_u32 v8, s13, v226
    s_waitcnt lgkmcnt(0)
    s_barrier
    ds_read_b128 v[24:27], v6 offset:0
    ds_read_b64_tr_b16 v[16:17], v7 offset:0
    ds_read_b64_tr_b16 v[18:19], v7 offset:2048
    ds_read_b128 v[28:31], v6 offset:2048
    ds_read_b128 v[32:35], v6 offset:4096
    ds_read_b64_tr_b16 v[20:21], v8 offset:0
    ds_read_b64_tr_b16 v[22:23], v8 offset:2048
    ds_read_b128 v[36:39], v6 offset:6144
    ds_read_b128 v[48:51], v6 offset:1024
    ds_read_b64_tr_b16 v[40:41], v7 offset:4096
    ds_read_b64_tr_b16 v[42:43], v7 offset:6144
    ds_read_b128 v[52:55], v6 offset:3072
    ds_read_b128 v[56:59], v6 offset:5120
    ds_read_b64_tr_b16 v[44:45], v8 offset:4096
    ds_read_b64_tr_b16 v[46:47], v8 offset:6144
    ds_read_b128 v[60:63], v6 offset:7168
    s_add_u32 s12, s12, 16384
    s_cmp_eq_u32 s12, 163840
    s_cselect_b32 s12, 0, s12
    s_cmp_eq_u32 s12, 16384
    s_cselect_b32 s12, 114688, s12
    s_add_u32 s13, s13, 8192
    s_cmp_ge_u32 s13, 81920
    s_cselect_b32 s13, 0, s13
    v_add_u32 v6, s12, v224
    v_add_u32 v7, s13, v225
    v_add_u32 v8, s13, v226
    s_waitcnt vmcnt(0)
    v_cmp_eq_u32 vcc, s88, v245
    s_nop 3
    s_cmp_eq_u64 vcc, -1
    s_cselect_b32 s95, 2, 1
    s_cmp_eq_u32 s95, 2
    s_cbranch_scc0 L_pbc_sf
L_pbc_ff:
    v_mov_b32 v253, 1
    s_mov_b64 exec, 1
    buffer_store_dword v253, v252, s[96:99], s89 offen
    s_mov_b64 exec, -1
L_pbc_go:
    s_waitcnt lgkmcnt(0)
    s_nop 1
L_g2c_loop4:
    s_barrier
    v_mfma_f32_16x16x32_bf16 v[192:195], v[16:19], v[24:27], v[192:195]
    ds_read_b128 v[72:75], v6 offset:0
    ds_read_b64_tr_b16 v[64:65], v7 offset:0
    v_mfma_f32_16x16x32_bf16 v[196:199], v[20:23], v[24:27], v[196:199]
    ds_read_b64_tr_b16 v[66:67], v7 offset:2048
    ds_read_b128 v[76:79], v6 offset:2048
    v_mfma_f32_16x16x32_bf16 v[200:203], v[16:19], v[28:31], v[200:203]
    ds_read_b128 v[80:83], v6 offset:4096
    ds_read_b64_tr_b16 v[68:69], v8 offset:0
    v_mfma_f32_16x16x32_bf16 v[204:207], v[20:23], v[28:31], v[204:207]
    ds_read_b64_tr_b16 v[70:71], v8 offset:2048
    ds_read_b128 v[84:87], v6 offset:6144
    v_mfma_f32_16x16x32_bf16 v[208:211], v[16:19], v[32:35], v[208:211]
    ds_read_b128 v[96:99], v6 offset:1024
    v_mfma_f32_16x16x32_bf16 v[212:215], v[20:23], v[32:35], v[212:215]
    ds_read_b64_tr_b16 v[88:89], v7 offset:4096
    v_mfma_f32_16x16x32_bf16 v[216:219], v[16:19], v[36:39], v[216:219]
    ds_read_b64_tr_b16 v[90:91], v7 offset:6144
    v_mfma_f32_16x16x32_bf16 v[220:223], v[20:23], v[36:39], v[220:223]
    ds_read_b128 v[100:103], v6 offset:3072
    v_mfma_f32_16x16x32_bf16 v[192:195], v[40:43], v[48:51], v[192:195]
    ds_read_b128 v[104:107], v6 offset:5120
    v_mfma_f32_16x16x32_bf16 v[196:199], v[44:47], v[48:51], v[196:199]
    ds_read_b64_tr_b16 v[92:93], v8 offset:4096
    v_mfma_f32_16x16x32_bf16 v[200:203], v[40:43], v[52:55], v[200:203]
    ds_read_b64_tr_b16 v[94:95], v8 offset:6144
    v_mfma_f32_16x16x32_bf16 v[204:207], v[44:47], v[52:55], v[204:207]
    ds_read_b128 v[108:111], v6 offset:7168
    v_mfma_f32_16x16x32_bf16 v[208:211], v[40:43], v[56:59], v[208:211]
    s_add_u32 s12, s12, 16384
    s_cmp_eq_u32 s12, 163840
    s_cselect_b32 s12, 0, s12
    v_mfma_f32_16x16x32_bf16 v[212:215], v[44:47], v[56:59], v[212:215]
    s_cmp_eq_u32 s12, 16384
    s_cselect_b32 s12, 114688, s12
    s_add_u32 s13, s13, 8192
    v_mfma_f32_16x16x32_bf16 v[216:219], v[40:43], v[60:63], v[216:219]
    s_cmp_ge_u32 s13, 81920
    s_cselect_b32 s13, 0, s13
    v_add_u32 v6, s12, v224
    v_mfma_f32_16x16x32_bf16 v[220:223], v[44:47], v[60:63], v[220:223]
    v_add_u32 v7, s13, v225
    v_add_u32 v8, s13, v226
    s_waitcnt lgkmcnt(0)
    s_barrier
    v_mfma_f32_16x16x32_bf16 v[192:195], v[64:67], v[72:75], v[192:195]
    ds_read_b128 v[24:27], v6 offset:0
    ds_read_b64_tr_b16 v[16:17], v7 offset:0
    v_mfma_f32_16x16x32_bf16 v[196:199], v[68:71], v[72:75], v[196:199]
    ds_read_b64_tr_b16 v[18:19], v7 offset:2048
    ds_read_b128 v[28:31], v6 offset:2048
    v_mfma_f32_16x16x32_bf16 v[200:203], v[64:67], v[76:79], v[200:203]
    ds_read_b128 v[32:35], v6 offset:4096
    ds_read_b64_tr_b16 v[20:21], v8 offset:0
    v_mfma_f32_16x16x32_bf16 v[204:207], v[68:71], v[76:79], v[204:207]
    ds_read_b64_tr_b16 v[22:23], v8 offset:2048
    ds_read_b128 v[36:39], v6 offset:6144
    v_mfma_f32_16x16x32_bf16 v[208:211], v[64:67], v[80:83], v[208:211]
    ds_read_b128 v[48:51], v6 offset:1024
    v_mfma_f32_16x16x32_bf16 v[212:215], v[68:71], v[80:83], v[212:215]
    ds_read_b64_tr_b16 v[40:41], v7 offset:4096
    v_mfma_f32_16x16x32_bf16 v[216:219], v[64:67], v[84:87], v[216:219]
    ds_read_b64_tr_b16 v[42:43], v7 offset:6144
    v_mfma_f32_16x16x32_bf16 v[220:223], v[68:71], v[84:87], v[220:223]
    ds_read_b128 v[52:55], v6 offset:3072
    v_mfma_f32_16x16x32_bf16 v[192:195], v[88:91], v[96:99], v[192:195]
    ds_read_b128 v[56:59], v6 offset:5120
    v_mfma_f32_16x16x32_bf16 v[196:199], v[92:95], v[96:99], v[196:199]
    ds_read_b64_tr_b16 v[44:45], v8 offset:4096
    v_mfma_f32_16x16x32_bf16 v[200:203], v[88:91], v[100:103], v[200:203]
    ds_read_b64_tr_b16 v[46:47], v8 offset:6144
    v_mfma_f32_16x16x32_bf16 v[204:207], v[92:95], v[100:103], v[204:207]
    ds_read_b128 v[60:63], v6 offset:7168
    v_mfma_f32_16x16x32_bf16 v[208:211], v[88:91], v[104:107], v[208:211]
    s_add_u32 s12, s12, 16384
    s_cmp_eq_u32 s12, 163840
    s_cselect_b32 s12, 0, s12
    v_mfma_f32_16x16x32_bf16 v[212:215], v[92:95], v[104:107], v[212:215]
    s_cmp_eq_u32 s12, 16384
    s_cselect_b32 s12, 114688, s12
    s_add_u32 s13, s13, 8192
    v_mfma_f32_16x16x32_bf16 v[216:219], v[88:91], v[108:111], v[216:219]
    s_cmp_ge_u32 s13, 81920
    s_cselect_b32 s13, 0, s13
    v_add_u32 v6, s12, v224
    v_mfma_f32_16x16x32_bf16 v[220:223], v[92:95], v[108:111], v[220:223]
    v_add_u32 v7, s13, v225
    v_add_u32 v8, s13, v226
    s_waitcnt lgkmcnt(0)
    s_add_u32 s15, s15, 1
    s_cmp_lt_u32 s15, 13
    s_cbranch_scc1 L_g2c_loop4
    v_mfma_f32_16x16x32_bf16 v[192:195], v[16:19], v[24:27], v[192:195]
    v_mfma_f32_16x16x32_bf16 v[196:199], v[20:23], v[24:27], v[196:199]
    v_mfma_f32_16x16x32_bf16 v[192:195], v[40:43], v[48:51], v[192:195]
    v_mfma_f32_16x16x32_bf16 v[196:199], v[44:47], v[48:51], v[196:199]
    v_mfma_f32_16x16x32_bf16 v[200:203], v[16:19], v[28:31], v[200:203]
    v_mfma_f32_16x16x32_bf16 v[204:207], v[20:23], v[28:31], v[204:207]
    v_mfma_f32_16x16x32_bf16 v[200:203], v[40:43], v[52:55], v[200:203]
    v_mfma_f32_16x16x32_bf16 v[204:207], v[44:47], v[52:55], v[204:207]
    v_mfma_f32_16x16x32_bf16 v[208:211], v[16:19], v[32:35], v[208:211]
    v_mfma_f32_16x16x32_bf16 v[212:215], v[20:23], v[32:35], v[212:215]
    v_mfma_f32_16x16x32_bf16 v[208:211], v[40:43], v[56:59], v[208:211]
    v_mfma_f32_16x16x32_bf16 v[212:215], v[44:47], v[56:59], v[212:215]
    v_mfma_f32_16x16x32_bf16 v[216:219], v[16:19], v[36:39], v[216:219]
    v_mfma_f32_16x16x32_bf16 v[220:223], v[20:23], v[36:39], v[220:223]
    v_mfma_f32_16x16x32_bf16 v[216:219], v[40:43], v[60:63], v[216:219]
    v_mfma_f32_16x16x32_bf16 v[220:223], v[44:47], v[60:63], v[220:223]
    v_xor_b32 v2, 0, v227
    v_xor_b32 v3, 32, v227
    v_xor_b32 v4, 64, v227
    v_xor_b32 v5, 96, v227
    s_mov_b32 s56, 0x3f80
    s_mov_b32 s57, 0x3f800000
    s_barrier
    ds_read_u16_d16_hi v234, v229 offset:57344
    ds_read_b64_tr_b16 v[144:145], v2 offset:0
    ds_read_b64_tr_b16 v[146:147], v2 offset:4096
    ds_read_u16_d16_hi v235, v229 offset:57376
    ds_read_b64_tr_b16 v[148:149], v3 offset:0
    ds_read_b64_tr_b16 v[150:151], v3 offset:4096
    ds_read_u16_d16_hi v236, v229 offset:57408
    ds_read_b64_tr_b16 v[152:153], v4 offset:0
    ds_read_b64_tr_b16 v[154:155], v4 offset:4096
    ds_read_u16_d16_hi v237, v229 offset:57440
    ds_read_b64_tr_b16 v[156:157], v5 offset:0
    ds_read_b64_tr_b16 v[158:159], v5 offset:4096
    v_cvt_pk_bf16_f32 v176, v192, v193
    v_cvt_pk_bf16_f32 v177, v194, v195
    v_cvt_pk_bf16_f32 v178, v196, v197
    v_cvt_pk_bf16_f32 v179, v198, v199
    v_cvt_pk_bf16_f32 v180, v200, v201
    v_cvt_pk_bf16_f32 v181, v202, v203
    v_cvt_pk_bf16_f32 v182, v204, v205
    v_cvt_pk_bf16_f32 v183, v206, v207
    v_cvt_pk_bf16_f32 v184, v208, v209
    v_cvt_pk_bf16_f32 v185, v210, v211
    v_cvt_pk_bf16_f32 v186, v212, v213
    v_cvt_pk_bf16_f32 v187, v214, v215
    v_cvt_pk_bf16_f32 v188, v216, v217
    v_cvt_pk_bf16_f32 v189, v218, v219
    v_cvt_pk_bf16_f32 v190, v220, v221
    v_cvt_pk_bf16_f32 v191, v222, v223
    s_waitcnt lgkmcnt(9)
    v_lshrrev_b32 v230, 16, v234
    v_dot2_f32_bf16 v193, v176, v234, 0
    v_dot2_f32_bf16 v195, v177, v234, 0
    v_dot2_f32_bf16 v197, v178, v234, 0
    v_dot2_f32_bf16 v199, v179, v234, 0
    v_dot2_f32_bf16 v192, v176, v230, 0
    v_dot2_f32_bf16 v194, v177, v230, 0
    v_dot2_f32_bf16 v196, v178, v230, 0
    v_dot2_f32_bf16 v198, v179, v230, 0
    v_lshlrev_b32 v112, 16, v144
    v_lshlrev_b32 v114, 16, v145
    v_lshlrev_b32 v116, 16, v146
    v_lshlrev_b32 v118, 16, v147
    v_cvt_pk_bf16_f32 v176, v192, v193
    v_cvt_pk_bf16_f32 v177, v194, v195
    v_cvt_pk_bf16_f32 v178, v196, v197
    v_cvt_pk_bf16_f32 v179, v198, v199
    v_and_b32 v113, s64, v144
    v_and_b32 v115, s64, v145
    v_and_b32 v117, s64, v146
    v_and_b32 v119, s64, v147
    v_dot2_f32_bf16 v192, v176, s56, v112
    v_dot2_f32_bf16 v194, v177, s56, v114
    v_dot2_f32_bf16 v196, v178, s56, v116
    v_dot2_f32_bf16 v198, v179, s56, v118
    v_dot2_f32_bf16 v193, v176, s57, v113
    v_dot2_f32_bf16 v195, v177, s57, v115
    v_dot2_f32_bf16 v197, v178, s57, v117
    v_dot2_f32_bf16 v199, v179, s57, v119
    v_cvt_pk_bf16_f32 v160, v192, v193
    v_cvt_pk_bf16_f32 v161, v194, v195
    v_cvt_pk_bf16_f32 v162, v196, v197
    v_cvt_pk_bf16_f32 v163, v198, v199
    s_nop 1
    v_permlane16_swap_b32 v160, v162
    v_permlane16_swap_b32 v161, v163
    buffer_store_dwordx4 v[160:163], v228, s[60:63], s65 offen sc1
    s_add_u32 s65, s65, 20480
    s_waitcnt lgkmcnt(6)
    v_lshrrev_b32 v231, 16, v235
    v_dot2_f32_bf16 v201, v180, v235, 0
    v_dot2_f32_bf16 v203, v181, v235, 0
    v_dot2_f32_bf16 v205, v182, v235, 0
    v_dot2_f32_bf16 v207, v183, v235, 0
    v_dot2_f32_bf16 v200, v180, v231, 0
    v_dot2_f32_bf16 v202, v181, v231, 0
    v_dot2_f32_bf16 v204, v182, v231, 0
    v_dot2_f32_bf16 v206, v183, v231, 0
    v_lshlrev_b32 v120, 16, v148
    v_lshlrev_b32 v122, 16, v149
    v_lshlrev_b32 v124, 16, v150
    v_lshlrev_b32 v126, 16, v151
    v_cvt_pk_bf16_f32 v180, v200, v201
    v_cvt_pk_bf16_f32 v181, v202, v203
    v_cvt_pk_bf16_f32 v182, v204, v205
    v_cvt_pk_bf16_f32 v183, v206, v207
    v_and_b32 v121, s64, v148
    v_and_b32 v123, s64, v149
    v_and_b32 v125, s64, v150
    v_and_b32 v127, s64, v151
    v_dot2_f32_bf16 v200, v180, s56, v120
    v_dot2_f32_bf16 v202, v181, s56, v122
    v_dot2_f32_bf16 v204, v182, s56, v124
    v_dot2_f32_bf16 v206, v183, s56, v126
    v_dot2_f32_bf16 v201, v180, s57, v121
    v_dot2_f32_bf16 v203, v181, s57, v123
    v_dot2_f32_bf16 v205, v182, s57, v125
    v_dot2_f32_bf16 v207, v183, s57, v127
    v_cvt_pk_bf16_f32 v164, v200, v201
    v_cvt_pk_bf16_f32 v165, v202, v203
    v_cvt_pk_bf16_f32 v166, v204, v205
    v_cvt_pk_bf16_f32 v167, v206, v207
    s_nop 1
    v_permlane16_swap_b32 v164, v166
    v_permlane16_swap_b32 v165, v167
    buffer_store_dwordx4 v[164:167], v228, s[60:63], s65 offen sc1
    s_add_u32 s65, s65, 20480
    s_waitcnt lgkmcnt(3)
    v_lshrrev_b32 v232, 16, v236
    v_dot2_f32_bf16 v209, v184, v236, 0
    v_dot2_f32_bf16 v211, v185, v236, 0
    v_dot2_f32_bf16 v213, v186, v236, 0
    v_dot2_f32_bf16 v215, v187, v236, 0
    v_dot2_f32_bf16 v208, v184, v232, 0
    v_dot2_f32_bf16 v210, v185, v232, 0
    v_dot2_f32_bf16 v212, v186, v232, 0
    v_dot2_f32_bf16 v214, v187, v232, 0
    v_lshlrev_b32 v128, 16, v152
    v_lshlrev_b32 v130, 16, v153
    v_lshlrev_b32 v132, 16, v154
    v_lshlrev_b32 v134, 16, v155
    v_cvt_pk_bf16_f32 v184, v208, v209
    v_cvt_pk_bf16_f32 v185, v210, v211
    v_cvt_pk_bf16_f32 v186, v212, v213
    v_cvt_pk_bf16_f32 v187, v214, v215
    v_and_b32 v129, s64, v152
    v_and_b32 v131, s64, v153
    v_and_b32 v133, s64, v154
    v_and_b32 v135, s64, v155
    v_dot2_f32_bf16 v208, v184, s56, v128
    v_dot2_f32_bf16 v210, v185, s56, v130
    v_dot2_f32_bf16 v212, v186, s56, v132
    v_dot2_f32_bf16 v214, v187, s56, v134
    v_dot2_f32_bf16 v209, v184, s57, v129
    v_dot2_f32_bf16 v211, v185, s57, v131
    v_dot2_f32_bf16 v213, v186, s57, v133
    v_dot2_f32_bf16 v215, v187, s57, v135
    v_cvt_pk_bf16_f32 v168, v208, v209
    v_cvt_pk_bf16_f32 v169, v210, v211
    v_cvt_pk_bf16_f32 v170, v212, v213
    v_cvt_pk_bf16_f32 v171, v214, v215
    s_nop 1
    v_permlane16_swap_b32 v168, v170
    v_permlane16_swap_b32 v169, v171
    buffer_store_dwordx4 v[168:171], v228, s[60:63], s65 offen sc1
    s_add_u32 s65, s65, 20480
    s_waitcnt lgkmcnt(0)
    v_lshrrev_b32 v233, 16, v237
    v_dot2_f32_bf16 v217, v188, v237, 0
    v_dot2_f32_bf16 v219, v189, v237, 0
    v_dot2_f32_bf16 v221, v190, v237, 0
    v_dot2_f32_bf16 v223, v191, v237, 0
    v_dot2_f32_bf16 v216, v188, v233, 0
    v_dot2_f32_bf16 v218, v189, v233, 0
    v_dot2_f32_bf16 v220, v190, v233, 0
    v_dot2_f32_bf16 v222, v191, v233, 0
    v_lshlrev_b32 v136, 16, v156
    v_lshlrev_b32 v138, 16, v157
    v_lshlrev_b32 v140, 16, v158
    v_lshlrev_b32 v142, 16, v159
    v_cvt_pk_bf16_f32 v188, v216, v217
    v_cvt_pk_bf16_f32 v189, v218, v219
    v_cvt_pk_bf16_f32 v190, v220, v221
    v_cvt_pk_bf16_f32 v191, v222, v223
    v_and_b32 v137, s64, v156
    v_and_b32 v139, s64, v157
    v_and_b32 v141, s64, v158
    v_and_b32 v143, s64, v159
    v_dot2_f32_bf16 v216, v188, s56, v136
    v_dot2_f32_bf16 v218, v189, s56, v138
    v_dot2_f32_bf16 v220, v190, s56, v140
    v_dot2_f32_bf16 v222, v191, s56, v142
    v_dot2_f32_bf16 v217, v188, s57, v137
    v_dot2_f32_bf16 v219, v189, s57, v139
    v_dot2_f32_bf16 v221, v190, s57, v141
    v_dot2_f32_bf16 v223, v191, s57, v143
    v_cvt_pk_bf16_f32 v172, v216, v217
    v_cvt_pk_bf16_f32 v173, v218, v219
    v_cvt_pk_bf16_f32 v174, v220, v221
    v_cvt_pk_bf16_f32 v175, v222, v223
    s_nop 1
    v_permlane16_swap_b32 v172, v174
    v_permlane16_swap_b32 v173, v175
    buffer_store_dwordx4 v[172:175], v228, s[60:63], s65 offen sc1
    s_endpgm
L_pbc_sf:
    s_lshl_b32 s90, s4, 8
    s_add_u32 s90, s90, 6656
    v_min_u32 v246, 21, v0
    v_lshlrev_b32 v246, 2, v246
    buffer_load_dword v245, v246, s[96:99], s90 offen sc1
    s_waitcnt vmcnt(0)
    v_cmp_eq_u32 vcc, s88, v245
    s_nop 3
    s_cmp_eq_u64 vcc, -1
    s_cselect_b32 s95, 2, 1
    s_cmp_eq_u32 s95, 2
    s_cbranch_scc1 L_pbc_ff
    v_mov_b32 v253, 1
    s_mov_b64 exec, 1
    buffer_store_dword v253, v252, s[96:99], s89 offen sc1
    s_mov_b64 exec, -1
    s_branch L_pbc_go
L_hpoll:
    buffer_load_dword v247, v248, s[96:99], 0 offen sc1
    s_waitcnt vmcnt(0)
    v_cmp_eq_u32 vcc, 1, v247
    s_nop 3
    s_ff0_i32_b64 s75, vcc
    s_lshr_b32 s75, s75, 2
    s_min_u32 s75, s75, 20
    s_mul_i32 s75, s75, 3
    s_add_u32 s75, s75, s72
    s_cmp_lt_u32 s69, s75
    s_cbranch_scc1 L_hpoll_ok
    s_sleep 1
    s_add_u32 s94, s94, 1
    s_cmp_lt_u32 s94, 0x100000
    s_cbranch_scc1 L_hpoll
L_hpoll_ok:
L_hps:
    s_add_u32 s78, s78, 4
    s_addc_u32 s79, s79, 0
    s_setpc_b64 s[78:79]
L_g2l_chk:
    s_getpc_b64 s[78:79]
    s_branch L_hpoll
    s_branch L_g2l_h
L_g2l_pre:
    buffer_load_dword v247, v248, s[96:99], 0 offen sc1
    s_mov_b32 m0, s67
    s_add_u32 s73, s73, 1
    buffer_load_dwordx4 v17, s[56:59], s66 offen lds
    buffer_load_dwordx4 v18, s[56:59], s66 offen offset:1024 lds
    v_readlane_b32 s66, v58, s73
    v_readlane_b32 s67, v59, s73
    s_mov_b32 m0, s61
    s_add_u32 s69, s69, 1
    buffer_load_dwordx4 v50, s[52:55], s60 offen sc1 lds
    buffer_load_dwordx4 v50, s[52:55], s60 offen offset:1024 sc1 lds
    buffer_load_dwordx4 v51, s[52:55], s60 offen offset:2048 sc1 lds
    buffer_load_dwordx4 v51, s[52:55], s60 offen offset:3072 sc1 lds
    v_readlane_b32 s60, v56, s69
    v_readlane_b32 s61, v57, s69
    s_waitcnt vmcnt(13)
    s_barrier
    s_mov_b32 m0, s67
    s_add_u32 s73, s73, 1
    buffer_load_dwordx4 v17, s[56:59], s66 offen lds
    buffer_load_dwordx4 v18, s[56:59], s66 offen offset:1024 lds
    v_readlane_b32 s66, v58, s73
    v_readlane_b32 s67, v59, s73
    s_mov_b32 m0, s61
    s_add_u32 s69, s69, 1
    buffer_load_dwordx4 v50, s[52:55], s60 offen sc1 lds
    buffer_load_dwordx4 v50, s[52:55], s60 offen offset:1024 sc1 lds
    buffer_load_dwordx4 v51, s[52:55], s60 offen offset:2048 sc1 lds
    buffer_load_dwordx4 v51, s[52:55], s60 offen offset:3072 sc1 lds
    v_readlane_b32 s60, v56, s69
    v_readlane_b32 s61, v57, s69
    s_waitcnt vmcnt(12)
    s_barrier
    v_cmp_eq_u32 vcc, 1, v247
    s_nop 3
    s_ff0_i32_b64 s15, vcc
    s_lshr_b32 s15, s15, 2
    s_min_u32 s15, s15, 20
    s_mul_i32 s15, s15, 3
    s_add_u32 s75, s15, s72
L_g2l_loop:
    s_mov_b32 m0, s67
    s_add_u32 s73, s73, 1
    buffer_load_dwordx4 v17, s[56:59], s66 offen lds
    buffer_load_dwordx4 v18, s[56:59], s66 offen offset:1024 lds
    v_readlane_b32 s66, v58, s73
    v_readlane_b32 s67, v59, s73
    s_cmp_lt_u32 s69, s75
    s_cbranch_scc0 L_g2l_chk
L_g2l_h:
    s_mov_b32 m0, s61
    s_add_u32 s69, s69, 1
    buffer_load_dwordx4 v50, s[52:55], s60 offen sc1 lds
    buffer_load_dwordx4 v50, s[52:55], s60 offen offset:1024 sc1 lds
    buffer_load_dwordx4 v51, s[52:55], s60 offen offset:2048 sc1 lds
    buffer_load_dwordx4 v51, s[52:55], s60 offen offset:3072 sc1 lds
    v_readlane_b32 s60, v56, s69
    v_readlane_b32 s61, v57, s69
    s_cmp_lt_u32 s69, 21
    s_waitcnt vmcnt(12)
    s_barrier
    s_cbranch_scc1 L_g2l_loop
    buffer_load_dword v250, v249, s[96:99], 0 offen sc1
    s_cmp_lt_u32 s69, s75
    s_cbranch_scc1 L_hk4
    s_getpc_b64 s[78:79]
    s_branch L_hpoll
L_hk4:
    s_mov_b32 m0, s61
    s_add_u32 s69, s69, 1
    buffer_load_dwordx4 v50, s[52:55], s60 offen sc1 lds
    buffer_load_dwordx4 v50, s[52:55], s60 offen offset:1024 sc1 lds
    buffer_load_dwordx4 v51, s[52:55], s60 offen offset:2048 sc1 lds
    buffer_load_dwordx4 v51, s[52:55], s60 offen offset:3072 sc1 lds
    v_readlane_b32 s60, v56, s69
    v_readlane_b32 s61, v57, s69
    s_waitcnt vmcnt(11)
    s_barrier
    s_nop 0
    s_mov_b32 m0, s61
    s_add_u32 s69, s69, 1
    buffer_load_dwordx4 v50, s[52:55], s60 offen sc1 lds
    buffer_load_dwordx4 v50, s[52:55], s60 offen offset:1024 sc1 lds
    buffer_load_dwordx4 v51, s[52:55], s60 offen offset:2048 sc1 lds
    buffer_load_dwordx4 v51, s[52:55], s60 offen offset:3072 sc1 lds
    v_readlane_b32 s60, v56, s69
    v_readlane_b32 s61, v57, s69
    s_lshl_b32 s15, s6, 2
    s_add_u32 s15, s15, s9
    s_lshl_b32 s15, s15, 16
    s_lshl_b32 s10, s7, 7
    s_add_u32 s10, s10, s70
    s_lshl_b32 s11, s10, 1
    s_add_u32 s11, s11, s15
    s_add_u32 s11, s11, 7340032
    s_lshl_b32 s10, s10, 2
    s_add_u32 s10, s10, 9961472
    s_mov_b32 s64, 0xffff0000
    s_lshl_b32 s15, s9, 12
    s_add_u32 s15, s15, 16384
    v_lshrrev_b32 v54, 4, v0
    v_lshlrev_b32 v54, 5, v54
    v_xor_b32 v54, v54, v50
    v_add_u32 v54, s15, v54
    v_xor_b32 v60, 128, v54
    v_lshrrev_b32 v55, 1, v53
    s_waitcnt vmcnt(8)
    s_barrier
    s_nop 0
    s_mov_b32 m0, s61
    s_add_u32 s69, s69, 1
    buffer_load_dwordx4 v50, s[52:55], s60 offen sc1 lds
    buffer_load_dwordx4 v50, s[52:55], s60 offen offset:1024 sc1 lds
    buffer_load_dwordx4 v51, s[52:55], s60 offen offset:2048 sc1 lds
    buffer_load_dwordx4 v51, s[52:55], s60 offen offset:3072 sc1 lds
    v_readlane_b32 s60, v56, s69
    v_readlane_b32 s61, v57, s69
L_g2l_yc:
    v_cmp_eq_u32 vcc, 1, v250
    s_nop 3
    s_cmp_eq_u64 vcc, -1
    s_cbranch_scc0 L_g2l_yw
L_g2l_yok:
    buffer_load_dwordx4 v[36:39], v53, s[52:55], s10 offen sc1
    buffer_load_dwordx4 v[40:43], v53, s[52:55], s10 offen offset:16 sc1
    buffer_load_dwordx4 v[20:23], v52, s[52:55], s11 offen sc1
    s_add_u32 s11, s11, 16384
    buffer_load_dwordx4 v[24:27], v52, s[52:55], s11 offen sc1
    s_add_u32 s11, s11, 16384
    buffer_load_dwordx4 v[28:31], v52, s[52:55], s11 offen sc1
    s_add_u32 s11, s11, 16384
    buffer_load_dwordx4 v[32:35], v52, s[52:55], s11 offen sc1
    s_cmp_eq_u32 s76, 0
    s_cbranch_scc1 L_hl_loop
    s_waitcnt vmcnt(14)
    s_barrier
    s_nop 0
    s_cmp_lt_u32 s69, s75
    s_cbranch_scc1 L_hk7
    s_getpc_b64 s[78:79]
    s_branch L_hpoll
L_hk7:
    s_mov_b32 m0, s61
    s_add_u32 s69, s69, 1
    buffer_load_dwordx4 v50, s[52:55], s60 offen sc1 lds
    buffer_load_dwordx4 v50, s[52:55], s60 offen offset:1024 sc1 lds
    buffer_load_dwordx4 v51, s[52:55], s60 offen offset:2048 sc1 lds
    buffer_load_dwordx4 v51, s[52:55], s60 offen offset:3072 sc1 lds
    v_readlane_b32 s60, v56, s69
    v_readlane_b32 s61, v57, s69
    s_waitcnt vmcnt(14)
    s_barrier
    s_nop 0
    s_mov_b32 m0, s61
    s_add_u32 s69, s69, 1
    buffer_load_dwordx4 v50, s[52:55], s60 offen sc1 lds
    buffer_load_dwordx4 v50, s[52:55], s60 offen offset:1024 sc1 lds
    buffer_load_dwordx4 v51, s[52:55], s60 offen offset:2048 sc1 lds
    buffer_load_dwordx4 v51, s[52:55], s60 offen offset:3072 sc1 lds
    v_readlane_b32 s60, v56, s69
    v_readlane_b32 s61, v57, s69
    s_waitcnt vmcnt(14)
    s_barrier
    s_nop 0
    s_mov_b32 m0, s61
    s_add_u32 s69, s69, 1
    buffer_load_dwordx4 v50, s[52:55], s60 offen sc1 lds
    buffer_load_dwordx4 v50, s[52:55], s60 offen offset:1024 sc1 lds
    buffer_load_dwordx4 v51, s[52:55], s60 offen offset:2048 sc1 lds
    buffer_load_dwordx4 v51, s[52:55], s60 offen offset:3072 sc1 lds
    v_readlane_b32 s60, v56, s69
    v_readlane_b32 s61, v57, s69
    s_setprio 2
    s_waitcnt vmcnt(8)
    s_barrier
    s_nop 0
    v_lshlrev_b32 v44, 16, v20
    v_and_b32 v45, s64, v20
    v_mul_f32 v44, v44, v36
    v_mul_f32 v45, v45, v37
    v_cvt_pk_bf16_f32 v20, v44, v45
    v_lshlrev_b32 v44, 16, v21
    v_and_b32 v45, s64, v21
    v_mul_f32 v44, v44, v38
    v_mul_f32 v45, v45, v39
    v_cvt_pk_bf16_f32 v21, v44, v45
    v_lshlrev_b32 v44, 16, v22
    v_and_b32 v45, s64, v22
    v_mul_f32 v44, v44, v40
    v_mul_f32 v45, v45, v41
    v_cvt_pk_bf16_f32 v22, v44, v45
    v_lshlrev_b32 v44, 16, v23
    v_and_b32 v45, s64, v23
    v_mul_f32 v44, v44, v42
    v_mul_f32 v45, v45, v43
    v_cvt_pk_bf16_f32 v23, v44, v45
    ds_write_b128 v54, v[20:23] offset:0
    s_waitcnt vmcnt(4)
    s_barrier
    s_nop 0
    v_lshlrev_b32 v44, 16, v24
    v_and_b32 v45, s64, v24
    v_mul_f32 v44, v44, v36
    v_mul_f32 v45, v45, v37
    v_cvt_pk_bf16_f32 v24, v44, v45
    v_lshlrev_b32 v44, 16, v25
    v_and_b32 v45, s64, v25
    v_mul_f32 v44, v44, v38
    v_mul_f32 v45, v45, v39
    v_cvt_pk_bf16_f32 v25, v44, v45
    v_lshlrev_b32 v44, 16, v26
    v_and_b32 v45, s64, v26
    v_mul_f32 v44, v44, v40
    v_mul_f32 v45, v45, v41
    v_cvt_pk_bf16_f32 v26, v44, v45
    v_lshlrev_b32 v44, 16, v27
    v_and_b32 v45, s64, v27
    v_mul_f32 v44, v44, v42
    v_mul_f32 v45, v45, v43
    v_cvt_pk_bf16_f32 v27, v44, v45
    ds_write_b128 v60, v[24:27] offset:1024
    s_waitcnt vmcnt(0)
    s_barrier
    s_nop 0
L_g2l_g2:
    v_lshlrev_b32 v44, 16, v28
    v_and_b32 v45, s64, v28
    v_mul_f32 v44, v44, v36
    v_mul_f32 v45, v45, v37
    v_cvt_pk_bf16_f32 v28, v44, v45
    v_lshlrev_b32 v44, 16, v29
    v_and_b32 v45, s64, v29
    v_mul_f32 v44, v44, v38
    v_mul_f32 v45, v45, v39
    v_cvt_pk_bf16_f32 v29, v44, v45
    v_lshlrev_b32 v44, 16, v30
    v_and_b32 v45, s64, v30
    v_mul_f32 v44, v44, v40
    v_mul_f32 v45, v45, v41
    v_cvt_pk_bf16_f32 v30, v44, v45
    v_lshlrev_b32 v44, 16, v31
    v_and_b32 v45, s64, v31
    v_mul_f32 v44, v44, v42
    v_mul_f32 v45, v45, v43
    v_cvt_pk_bf16_f32 v31, v44, v45
    ds_write_b128 v54, v[28:31] offset:2048
    v_lshlrev_b32 v44, 16, v32
    v_and_b32 v45, s64, v32
    v_mul_f32 v44, v44, v36
    v_mul_f32 v45, v45, v37
    v_cvt_pk_bf16_f32 v32, v44, v45
    v_lshlrev_b32 v44, 16, v33
    v_and_b32 v45, s64, v33
    v_mul_f32 v44, v44, v38
    v_mul_f32 v45, v45, v39
    v_cvt_pk_bf16_f32 v33, v44, v45
    v_lshlrev_b32 v44, 16, v34
    v_and_b32 v45, s64, v34
    v_mul_f32 v44, v44, v40
    v_mul_f32 v45, v45, v41
    v_cvt_pk_bf16_f32 v34, v44, v45
    v_lshlrev_b32 v44, 16, v35
    v_and_b32 v45, s64, v35
    v_mul_f32 v44, v44, v42
    v_mul_f32 v45, v45, v43
    v_cvt_pk_bf16_f32 v35, v44, v45
    ds_write_b128 v60, v[32:35] offset:3072
    v_sub_f32 v44, 1.0, v36
    v_sub_f32 v45, 1.0, v37
    v_cvt_pk_bf16_f32 v46, v44, v45
    v_sub_f32 v44, 1.0, v38
    v_sub_f32 v45, 1.0, v39
    v_cvt_pk_bf16_f32 v47, v44, v45
    v_sub_f32 v44, 1.0, v40
    v_sub_f32 v45, 1.0, v41
    v_cvt_pk_bf16_f32 v48, v44, v45
    v_sub_f32 v44, 1.0, v42
    v_sub_f32 v45, 1.0, v43
    v_cvt_pk_bf16_f32 v49, v44, v45
    ds_write_b128 v55, v[46:49] offset:57344
    s_waitcnt lgkmcnt(0)
    s_barrier
    s_endpgm
L_g2l_yw:
    s_add_u32 s94, s94, 1
    s_cmp_lt_u32 s94, 0x100000
    s_cbranch_scc0 L_g2l_yok
    s_sleep 12
    buffer_load_dword v250, v249, s[96:99], 0 offen sc1
    s_waitcnt vmcnt(0)
    s_branch L_g2l_yc
L_hl_loop:
    s_sub_u32 s15, s69, 4
    s_cmp_lt_u32 s15, 17
    s_cbranch_scc0 L_hl_nw
    s_mov_b32 m0, s67
    s_add_u32 s73, s73, 1
    buffer_load_dwordx4 v17, s[56:59], s66 offen lds
    buffer_load_dwordx4 v18, s[56:59], s66 offen offset:1024 lds
    v_readlane_b32 s66, v58, s73
    v_readlane_b32 s67, v59, s73
L_hl_nw:
    s_cmp_lt_u32 s69, s75
    s_cbranch_scc1 L_hl_h
    s_getpc_b64 s[78:79]
    s_branch L_hpoll
L_hl_h:
    s_mov_b32 m0, s61
    s_add_u32 s69, s69, 1
    buffer_load_dwordx4 v50, s[52:55], s60 offen sc1 lds
    buffer_load_dwordx4 v50, s[52:55], s60 offen offset:1024 sc1 lds
    v_readlane_b32 s60, v56, s69
    v_readlane_b32 s61, v57, s69
    s_cmp_lt_u32 s69, 3
    s_cbranch_scc1 L_hl_loop
    s_sub_u32 s15, s69, 6
    s_cmp_lt_u32 s15, 16
    s_cbranch_scc1 L_hl_w8
    s_waitcnt vmcnt(4)
L_hl_w8:
    s_waitcnt vmcnt(8)
    s_barrier
    s_cmp_eq_u32 s69, 22
    s_cbranch_scc1 L_hl_y
    s_cmp_eq_u32 s69, 24
    s_cbranch_scc1 L_g2l_yc
    s_cmp_lt_u32 s69, 27
    s_cbranch_scc1 L_hl_loop
    s_waitcnt vmcnt(2)
    s_barrier
    s_waitcnt vmcnt(0)
    v_lshlrev_b32 v44, 16, v20
    v_and_b32 v45, s64, v20
    v_mul_f32 v44, v44, v36
    v_mul_f32 v45, v45, v37
    v_cvt_pk_bf16_f32 v20, v44, v45
    v_lshlrev_b32 v44, 16, v21
    v_and_b32 v45, s64, v21
    v_mul_f32 v44, v44, v38
    v_mul_f32 v45, v45, v39
    v_cvt_pk_bf16_f32 v21, v44, v45
    v_lshlrev_b32 v44, 16, v22
    v_and_b32 v45, s64, v22
    v_mul_f32 v44, v44, v40
    v_mul_f32 v45, v45, v41
    v_cvt_pk_bf16_f32 v22, v44, v45
    v_lshlrev_b32 v44, 16, v23
    v_and_b32 v45, s64, v23
    v_mul_f32 v44, v44, v42
    v_mul_f32 v45, v45, v43
    v_cvt_pk_bf16_f32 v23, v44, v45
    ds_write_b128 v54, v[20:23] offset:0
    s_barrier
    v_lshlrev_b32 v44, 16, v24
    v_and_b32 v45, s64, v24
    v_mul_f32 v44, v44, v36
    v_mul_f32 v45, v45, v37
    v_cvt_pk_bf16_f32 v24, v44, v45
    v_lshlrev_b32 v44, 16, v25
    v_and_b32 v45, s64, v25
    v_mul_f32 v44, v44, v38
    v_mul_f32 v45, v45, v39
    v_cvt_pk_bf16_f32 v25, v44, v45
    v_lshlrev_b32 v44, 16, v26
    v_and_b32 v45, s64, v26
    v_mul_f32 v44, v44, v40
    v_mul_f32 v45, v45, v41
    v_cvt_pk_bf16_f32 v26, v44, v45
    v_lshlrev_b32 v44, 16, v27
    v_and_b32 v45, s64, v27
    v_mul_f32 v44, v44, v42
    v_mul_f32 v45, v45, v43
    v_cvt_pk_bf16_f32 v27, v44, v45
    ds_write_b128 v60, v[24:27] offset:1024
    s_branch L_g2l_g2
L_hl_y:
    buffer_load_dword v250, v249, s[96:99], 0 offen sc1
    s_lshl_b32 s15, s6, 2
    s_add_u32 s15, s15, s9
    s_lshl_b32 s15, s15, 16
    s_lshl_b32 s10, s7, 7
    s_add_u32 s10, s10, s70
    s_lshl_b32 s11, s10, 1
    s_add_u32 s11, s11, s15
    s_add_u32 s11, s11, 7340032
    s_lshl_b32 s10, s10, 2
    s_add_u32 s10, s10, 9961472
    s_mov_b32 s64, 0xffff0000
    s_lshl_b32 s15, s9, 12
    s_add_u32 s15, s15, 16384
    v_lshrrev_b32 v54, 4, v0
    v_lshlrev_b32 v54, 5, v54
    v_xor_b32 v54, v54, v50
    v_add_u32 v54, s15, v54
    v_xor_b32 v60, 128, v54
    v_lshrrev_b32 v55, 1, v53
    s_branch L_hl_loop
L_not_g1:
    s_cmp_ge_u32 s5, 22
    s_cbranch_scc1 L_ssm
    s_sub_u32 s8, s5, 18
    s_waitcnt lgkmcnt(0)
    s_mov_b32 s84, s40
    s_mov_b32 s85, s41
    s_mov_b32 s86, 0x100
    s_mov_b32 s87, 0x00020000
    s_add_u32 s96, s42, 0x990000
    s_addc_u32 s97, s43, 0
    s_mov_b32 s98, 0x2200
    s_mov_b32 s99, 0x00020000
    s_cmp_eq_u32 s2, 168
    s_cbranch_scc0 L_hp_nc
    s_lshl_b32 s9, s3, 10
    v_lshl_add_u32 v2, v0, 4, s9
    v_mov_b32 v4, 0
    v_mov_b32 v5, 0
    v_mov_b32 v6, 0
    v_mov_b32 v7, 0
    s_movk_i32 s9, 0x2000
    buffer_store_dwordx4 v[4:7], v2, s[96:99], 0 offen sc1
    buffer_store_dwordx4 v[4:7], v2, s[96:99], s9 offen sc1
    s_waitcnt vmcnt(0)
    s_barrier
    s_cmp_eq_u32 s3, 0
    s_cbranch_scc0 L_hp_nc
    v_mov_b32 v5, 1
    s_mov_b64 exec, 1
    buffer_store_dword v5, v4, s[84:87], 0 offen sc1
    s_mov_b64 exec, -1
L_hp_nc:
    s_mov_b32 s56, s34
    s_mov_b32 s57, s35
    s_mov_b32 s58, 0x21c000
    s_mov_b32 s59, 0x00020000
    v_min_u32 v5, 59, v0
    v_mul_u32_u24 v6, 6554, v5
    v_lshrrev_b32 v6, 16, v6
    v_mul_u32_u24 v7, 10, v6
    v_sub_u32 v7, v5, v7
    v_mul_u32_u24 v5, 192, v7
    v_add_u32 v5, v5, v6
    v_lshlrev_b32 v7, 7, v7
    s_lshl_b32 s10, s8, 3
    s_add_u32 s10, s10, s3
    s_mul_i32 s10, s10, 6
    s_cmp_eq_u32 s3, 0
    s_cbranch_scc0 L_hp_nj
    buffer_load_dword v251, v252, s[84:87], 0 offen sc1
L_join1:
    s_waitcnt vmcnt(0)
    v_readfirstlane_b32 s90, v251
    s_lshl_b32 s91, s4, 6
    s_add_u32 s91, s91, s5
    s_lshl_b32 s91, s91, 2
    s_add_u32 s91, s91, 6656
    s_cmp_eq_u32 s90, 1
    s_cbranch_scc1 L_joined1
    s_sleep 4
    buffer_load_dword v251, v252, s[84:87], 0 offen sc1
    s_add_u32 s94, s94, 1
    s_cmp_lt_u32 s94, 0x100000
    s_cbranch_scc1 L_join1
L_joined1:
    v_mov_b32 v253, s88
    s_mov_b64 exec, 1
    buffer_store_dword v253, v252, s[96:99], s91 offen sc1
    s_mov_b64 exec, -1
L_hp_nj:
    s_barrier
L_hp_go:
    s_add_u32 s11, s4, 0
    s_and_b32 s11, s11, 3
    s_mul_i32 s11, s11, 192
    s_add_u32 s11, s11, s10
    v_add_u32 v8, s11, v5
    v_subrev_u32 v9, 1728, v8
    v_min_u32 v8, v8, v9
    v_mul_u32_u24 v8, 1280, v8
    v_add_u32 v8, v8, v7
    buffer_load_dword v20, v8, s[56:59], 0 offen
    s_add_u32 s11, s4, 1
    s_and_b32 s11, s11, 3
    s_mul_i32 s11, s11, 192
    s_add_u32 s11, s11, s10
    v_add_u32 v8, s11, v5
    v_subrev_u32 v9, 1728, v8
    v_min_u32 v8, v8, v9
    v_mul_u32_u24 v8, 1280, v8
    v_add_u32 v8, v8, v7
    buffer_load_dword v21, v8, s[56:59], 0 offen
    s_add_u32 s11, s4, 2
    s_and_b32 s11, s11, 3
    s_mul_i32 s11, s11, 192
    s_add_u32 s11, s11, s10
    v_add_u32 v8, s11, v5
    v_subrev_u32 v9, 1728, v8
    v_min_u32 v8, v8, v9
    v_mul_u32_u24 v8, 1280, v8
    v_add_u32 v8, v8, v7
    buffer_load_dword v22, v8, s[56:59], 0 offen
    s_add_u32 s11, s4, 3
    s_and_b32 s11, s11, 3
    s_mul_i32 s11, s11, 192
    s_add_u32 s11, s11, s10
    v_add_u32 v8, s11, v5
    v_subrev_u32 v9, 1728, v8
    v_min_u32 v8, v8, v9
    v_mul_u32_u24 v8, 1280, v8
    v_add_u32 v8, v8, v7
    buffer_load_dword v23, v8, s[56:59], 0 offen
    s_lshl_b32 s11, s8, 3
    s_add_u32 s11, s11, s3
    s_lshl_b32 s11, s11, 3
    s_add_u32 s11, s11, s4
    s_lshl_b32 s11, s11, 2
    s_add_u32 s11, s11, 768
    s_min_u32 s11, s11, 1722
    s_mov_b32 exec_hi, 0xff
    v_add_u32 v8, s11, v5
    v_subrev_u32 v9, 1728, v8
    v_min_u32 v8, v8, v9
    v_mul_u32_u24 v8, 1280, v8
    v_add_u32 v8, v8, v7
    buffer_load_dword v25, v8, s[56:59], 0 offen
    s_mov_b32 exec_hi, -1
    s_barrier
    s_waitcnt vmcnt(0)
    s_lshr_b32 s70, s8, 1
    s_lshl_b32 s70, s70, 6
    s_nop 0
    s_and_b32 s7, s5, 1
    s_lshr_b32 s6, s5, 1
    s_lshl_b32 s8, s4, 1
    s_add_u32 s7, s7, s8
    s_mov_b32 s6, 9
    s_mov_b32 s76, 0
    s_cmp_lt_u32 s3, 4
    s_cbranch_scc0 L_hp_l
    s_lshr_b32 s8, s3, 1
    s_and_b32 s9, s3, 1
    s_mov_b32 s60, s38
    s_mov_b32 s61, s39
    s_mov_b32 s62, 0x280000
    s_mov_b32 s63, 0x00020000
    v_and_b32 v230, 15, v0
    v_lshrrev_b32 v231, 4, v0
    s_lshl_b32 s58, s8, s76
    s_lshl_b32 s56, s58, 12
    v_lshl_add_u32 v224, v0, 4, s56
    v_lshrrev_b32 v232, 2, v0
    v_lshlrev_b32 v233, 7, v232
    v_and_b32 v232, 3, v0
    v_lshl_add_u32 v233, v232, 3, v233
    v_add_u32 v233, 32768, v233
    v_bfe_u32 v232, v0, 3, 2
    s_lshl_b32 s56, s9, 1
    v_xor_b32 v232, s56, v232
    v_lshl_add_u32 v225, v232, 5, v233
    v_xor_b32 v232, 1, v232
    v_lshl_add_u32 v226, v232, 5, v233
    v_lshrrev_b32 v232, 2, v0
    v_lshlrev_b32 v227, 8, v232
    v_and_b32 v232, 3, v0
    v_lshl_add_u32 v227, v232, 3, v227
    s_lshl_b32 s56, s9, 13
    s_lshl_b32 s57, s58, 6
    s_add_u32 s56, s56, s57
    s_add_u32 s56, s56, 16384
    v_add_u32 v227, s56, v227
    v_bfe_u32 v232, v0, 2, 3
    v_lshlrev_b32 v232, 5, v232
    v_xor_b32 v227, v227, v232
    v_lshl_add_u32 v229, v230, 1, s57
    v_mul_u32_u24 v228, 1280, v230
    v_and_b32 v232, 1, v231
    v_lshl_add_u32 v228, v232, 5, v228
    v_lshrrev_b32 v232, 1, v231
    v_lshl_add_u32 v228, v232, 4, v228
    s_lshl_b32 s56, s7, 2
    s_add_u32 s56, s56, s58
    s_mul_i32 s65, s56, 40960
    s_lshl_b32 s56, s6, 7
    s_add_u32 s65, s65, s56
    s_lshl_b32 s56, s9, 6
    s_add_u32 s65, s65, s56
    s_mul_i32 s56, s70, 1280
    s_add_u32 s65, s65, s56
    s_mov_b32 s64, 0xffff0000
    v_mov_b32 v192, 0
    v_mov_b32 v193, 0
    v_mov_b32 v194, 0
    v_mov_b32 v195, 0
    v_mov_b32 v196, 0
    v_mov_b32 v197, 0
    v_mov_b32 v198, 0
    v_mov_b32 v199, 0
    v_mov_b32 v200, 0
    v_mov_b32 v201, 0
    v_mov_b32 v202, 0
    v_mov_b32 v203, 0
    v_mov_b32 v204, 0
    v_mov_b32 v205, 0
    v_mov_b32 v206, 0
    v_mov_b32 v207, 0
    v_mov_b32 v208, 0
    v_mov_b32 v209, 0
    v_mov_b32 v210, 0
    v_mov_b32 v211, 0
    v_mov_b32 v212, 0
    v_mov_b32 v213, 0
    v_mov_b32 v214, 0
    v_mov_b32 v215, 0
    v_mov_b32 v216, 0
    v_mov_b32 v217, 0
    v_mov_b32 v218, 0
    v_mov_b32 v219, 0
    v_mov_b32 v220, 0
    v_mov_b32 v221, 0
    v_mov_b32 v222, 0
    v_mov_b32 v223, 0
    v_mov_b32 v234, 0
    v_mov_b32 v235, 0
    v_mov_b32 v236, 0
    v_mov_b32 v237, 0
    s_mov_b32 s12, 114688
    s_mov_b32 s13, 49152
    s_mov_b32 s15, 0
    v_add_u32 v6, s12, v224
    v_add_u32 v7, s13, v225
    v_add_u32 v8, s13, v226
    s_waitcnt lgkmcnt(0)
    s_barrier
    ds_read_b128 v[24:27], v6 offset:0
    ds_read_b64_tr_b16 v[16:17], v7 offset:0
    ds_read_b64_tr_b16 v[18:19], v7 offset:2048
    ds_read_b128 v[28:31], v6 offset:2048
    ds_read_b64_tr_b16 v[20:21], v8 offset:0
    ds_read_b64_tr_b16 v[22:23], v8 offset:2048
    ds_read_b128 v[48:51], v6 offset:1024
    ds_read_b64_tr_b16 v[40:41], v7 offset:4096
    ds_read_b64_tr_b16 v[42:43], v7 offset:6144
    ds_read_b128 v[52:55], v6 offset:3072
    ds_read_b64_tr_b16 v[44:45], v8 offset:4096
    ds_read_b64_tr_b16 v[46:47], v8 offset:6144
    s_add_u32 s12, s12, 16384
    s_cmp_eq_u32 s12, 163840
    s_cselect_b32 s12, 0, s12
    s_cmp_eq_u32 s12, 16384
    s_cselect_b32 s12, 114688, s12
    s_add_u32 s13, s13, 8192
    s_cmp_ge_u32 s13, 81920
    s_cselect_b32 s13, 0, s13
    v_add_u32 v6, s12, v224
    v_add_u32 v7, s13, v225
    v_add_u32 v8, s13, v226
    s_waitcnt lgkmcnt(0)
    s_nop 1
L_g2c_loop2:
    s_barrier
    v_mfma_f32_16x16x32_bf16 v[192:195], v[16:19], v[24:27], v[192:195]
    ds_read_b128 v[72:75], v6 offset:0
    ds_read_b64_tr_b16 v[64:65], v7 offset:0
    ds_read_b64_tr_b16 v[66:67], v7 offset:2048
    v_mfma_f32_16x16x32_bf16 v[196:199], v[20:23], v[24:27], v[196:199]
    ds_read_b128 v[76:79], v6 offset:2048
    ds_read_b64_tr_b16 v[68:69], v8 offset:0
    ds_read_b64_tr_b16 v[70:71], v8 offset:2048
    v_mfma_f32_16x16x32_bf16 v[200:203], v[16:19], v[28:31], v[200:203]
    ds_read_b128 v[96:99], v6 offset:1024
    ds_read_b64_tr_b16 v[88:89], v7 offset:4096
    ds_read_b64_tr_b16 v[90:91], v7 offset:6144
    v_mfma_f32_16x16x32_bf16 v[204:207], v[20:23], v[28:31], v[204:207]
    ds_read_b128 v[100:103], v6 offset:3072
    ds_read_b64_tr_b16 v[92:93], v8 offset:4096
    ds_read_b64_tr_b16 v[94:95], v8 offset:6144
    v_mfma_f32_16x16x32_bf16 v[192:195], v[40:43], v[48:51], v[192:195]
    s_add_u32 s12, s12, 16384
    s_cmp_eq_u32 s12, 163840
    s_cselect_b32 s12, 0, s12
    v_mfma_f32_16x16x32_bf16 v[196:199], v[44:47], v[48:51], v[196:199]
    s_cmp_eq_u32 s12, 16384
    s_cselect_b32 s12, 114688, s12
    s_add_u32 s13, s13, 8192
    v_mfma_f32_16x16x32_bf16 v[200:203], v[40:43], v[52:55], v[200:203]
    s_cmp_ge_u32 s13, 81920
    s_cselect_b32 s13, 0, s13
    v_add_u32 v6, s12, v224
    v_mfma_f32_16x16x32_bf16 v[204:207], v[44:47], v[52:55], v[204:207]
    v_add_u32 v7, s13, v225
    v_add_u32 v8, s13, v226
    s_waitcnt lgkmcnt(0)
    s_barrier
    v_mfma_f32_16x16x32_bf16 v[192:195], v[64:67], v[72:75], v[192:195]
    ds_read_b128 v[24:27], v6 offset:0
    ds_read_b64_tr_b16 v[16:17], v7 offset:0
    ds_read_b64_tr_b16 v[18:19], v7 offset:2048
    v_mfma_f32_16x16x32_bf16 v[196:199], v[68:71], v[72:75], v[196:199]
    ds_read_b128 v[28:31], v6 offset:2048
    ds_read_b64_tr_b16 v[20:21], v8 offset:0
    ds_read_b64_tr_b16 v[22:23], v8 offset:2048
    v_mfma_f32_16x16x32_bf16 v[200:203], v[64:67], v[76:79], v[200:203]
    ds_read_b128 v[48:51], v6 offset:1024
    ds_read_b64_tr_b16 v[40:41], v7 offset:4096
    ds_read_b64_tr_b16 v[42:43], v7 offset:6144
    v_mfma_f32_16x16x32_bf16 v[204:207], v[68:71], v[76:79], v[204:207]
    ds_read_b128 v[52:55], v6 offset:3072
    ds_read_b64_tr_b16 v[44:45], v8 offset:4096
    ds_read_b64_tr_b16 v[46:47], v8 offset:6144
    v_mfma_f32_16x16x32_bf16 v[192:195], v[88:91], v[96:99], v[192:195]
    s_add_u32 s12, s12, 16384
    s_cmp_eq_u32 s12, 163840
    s_cselect_b32 s12, 0, s12
    v_mfma_f32_16x16x32_bf16 v[196:199], v[92:95], v[96:99], v[196:199]
    s_cmp_eq_u32 s12, 16384
    s_cselect_b32 s12, 114688, s12
    s_add_u32 s13, s13, 8192
    v_mfma_f32_16x16x32_bf16 v[200:203], v[88:91], v[100:103], v[200:203]
    s_cmp_ge_u32 s13, 81920
    s_cselect_b32 s13, 0, s13
    v_add_u32 v6, s12, v224
    v_mfma_f32_16x16x32_bf16 v[204:207], v[92:95], v[100:103], v[204:207]
    v_add_u32 v7, s13, v225
    v_add_u32 v8, s13, v226
    s_waitcnt lgkmcnt(0)
    s_add_u32 s15, s15, 1
    s_cmp_lt_u32 s15, 13
    s_cbranch_scc1 L_g2c_loop2
    v_mfma_f32_16x16x32_bf16 v[192:195], v[16:19], v[24:27], v[192:195]
    v_mfma_f32_16x16x32_bf16 v[196:199], v[20:23], v[24:27], v[196:199]
    v_mfma_f32_16x16x32_bf16 v[192:195], v[40:43], v[48:51], v[192:195]
    v_mfma_f32_16x16x32_bf16 v[196:199], v[44:47], v[48:51], v[196:199]
    v_mfma_f32_16x16x32_bf16 v[200:203], v[16:19], v[28:31], v[200:203]
    v_mfma_f32_16x16x32_bf16 v[204:207], v[20:23], v[28:31], v[204:207]
    v_mfma_f32_16x16x32_bf16 v[200:203], v[40:43], v[52:55], v[200:203]
    v_mfma_f32_16x16x32_bf16 v[204:207], v[44:47], v[52:55], v[204:207]
    v_xor_b32 v2, 0, v227
    v_xor_b32 v3, 32, v227
    s_mov_b32 s56, 0x3f80
    s_mov_b32 s57, 0x3f800000
    s_barrier
    ds_read_u16_d16_hi v234, v229 offset:57344
    ds_read_b64_tr_b16 v[144:145], v2 offset:0
    ds_read_b64_tr_b16 v[146:147], v2 offset:4096
    ds_read_u16_d16_hi v235, v229 offset:57376
    ds_read_b64_tr_b16 v[148:149], v3 offset:0
    ds_read_b64_tr_b16 v[150:151], v3 offset:4096
    v_cvt_pk_bf16_f32 v176, v192, v193
    v_cvt_pk_bf16_f32 v177, v194, v195
    v_cvt_pk_bf16_f32 v178, v196, v197
    v_cvt_pk_bf16_f32 v179, v198, v199
    v_cvt_pk_bf16_f32 v180, v200, v201
    v_cvt_pk_bf16_f32 v181, v202, v203
    v_cvt_pk_bf16_f32 v182, v204, v205
    v_cvt_pk_bf16_f32 v183, v206, v207
    s_waitcnt lgkmcnt(3)
    v_lshrrev_b32 v230, 16, v234
    v_dot2_f32_bf16 v193, v176, v234, 0
    v_dot2_f32_bf16 v195, v177, v234, 0
    v_dot2_f32_bf16 v197, v178, v234, 0
    v_dot2_f32_bf16 v199, v179, v234, 0
    v_dot2_f32_bf16 v192, v176, v230, 0
    v_dot2_f32_bf16 v194, v177, v230, 0
    v_dot2_f32_bf16 v196, v178, v230, 0
    v_dot2_f32_bf16 v198, v179, v230, 0
    v_lshlrev_b32 v112, 16, v144
    v_lshlrev_b32 v114, 16, v145
    v_lshlrev_b32 v116, 16, v146
    v_lshlrev_b32 v118, 16, v147
    v_cvt_pk_bf16_f32 v176, v192, v193
    v_cvt_pk_bf16_f32 v177, v194, v195
    v_cvt_pk_bf16_f32 v178, v196, v197
    v_cvt_pk_bf16_f32 v179, v198, v199
    v_and_b32 v113, s64, v144
    v_and_b32 v115, s64, v145
    v_and_b32 v117, s64, v146
    v_and_b32 v119, s64, v147
    v_dot2_f32_bf16 v192, v176, s56, v112
    v_dot2_f32_bf16 v194, v177, s56, v114
    v_dot2_f32_bf16 v196, v178, s56, v116
    v_dot2_f32_bf16 v198, v179, s56, v118
    v_dot2_f32_bf16 v193, v176, s57, v113
    v_dot2_f32_bf16 v195, v177, s57, v115
    v_dot2_f32_bf16 v197, v178, s57, v117
    v_dot2_f32_bf16 v199, v179, s57, v119
    v_cvt_pk_bf16_f32 v160, v192, v193
    v_cvt_pk_bf16_f32 v161, v194, v195
    v_cvt_pk_bf16_f32 v162, v196, v197
    v_cvt_pk_bf16_f32 v163, v198, v199
    s_nop 1
    v_permlane16_swap_b32 v160, v162
    v_permlane16_swap_b32 v161, v163
    buffer_store_dwordx4 v[160:163], v228, s[60:63], s65 offen sc1
    s_add_u32 s65, s65, 20480
    s_waitcnt lgkmcnt(0)
    v_lshrrev_b32 v231, 16, v235
    v_dot2_f32_bf16 v201, v180, v235, 0
    v_dot2_f32_bf16 v203, v181, v235, 0
    v_dot2_f32_bf16 v205, v182, v235, 0
    v_dot2_f32_bf16 v207, v183, v235, 0
    v_dot2_f32_bf16 v200, v180, v231, 0
    v_dot2_f32_bf16 v202, v181, v231, 0
    v_dot2_f32_bf16 v204, v182, v231, 0
    v_dot2_f32_bf16 v206, v183, v231, 0
    v_lshlrev_b32 v120, 16, v148
    v_lshlrev_b32 v122, 16, v149
    v_lshlrev_b32 v124, 16, v150
    v_lshlrev_b32 v126, 16, v151
    v_cvt_pk_bf16_f32 v180, v200, v201
    v_cvt_pk_bf16_f32 v181, v202, v203
    v_cvt_pk_bf16_f32 v182, v204, v205
    v_cvt_pk_bf16_f32 v183, v206, v207
    v_and_b32 v121, s64, v148
    v_and_b32 v123, s64, v149
    v_and_b32 v125, s64, v150
    v_and_b32 v127, s64, v151
    v_dot2_f32_bf16 v200, v180, s56, v120
    v_dot2_f32_bf16 v202, v181, s56, v122
    v_dot2_f32_bf16 v204, v182, s56, v124
    v_dot2_f32_bf16 v206, v183, s56, v126
    v_dot2_f32_bf16 v201, v180, s57, v121
    v_dot2_f32_bf16 v203, v181, s57, v123
    v_dot2_f32_bf16 v205, v182, s57, v125
    v_dot2_f32_bf16 v207, v183, s57, v127
    v_cvt_pk_bf16_f32 v164, v200, v201
    v_cvt_pk_bf16_f32 v165, v202, v203
    v_cvt_pk_bf16_f32 v166, v204, v205
    v_cvt_pk_bf16_f32 v167, v206, v207
    s_nop 1
    v_permlane16_swap_b32 v164, v166
    v_permlane16_swap_b32 v165, v167
    buffer_store_dwordx4 v[164:167], v228, s[60:63], s65 offen sc1
    s_endpgm
L_hp_l:
    s_sub_u32 s9, s3, 4
    s_mov_b32 s56, s34
    s_mov_b32 s57, s35
    s_mov_b32 s58, 0x21c000
    s_mov_b32 s59, 0x00020000
    s_mov_b32 s52, s42
    s_mov_b32 s53, s43
    s_mov_b32 s54, 0x990000
    s_mov_b32 s55, 0x00020000
    v_lshrrev_b32 v2, 3, v0
    v_mul_u32_u24 v17, 1280, v2
    v_and_b32 v3, 7, v0
    v_and_b32 v2, 6, v2
    v_xor_b32 v3, v3, v2
    v_lshl_add_u32 v17, v3, 4, v17
    v_add_u32 v18, 9216, v17
    s_mul_i32 s68, s6, 3
    v_min_u32 v2, 26, v0
    v_add_u32 v2, s68, v2
    v_subrev_u32 v3, 27, v2
    v_min_u32 v2, v2, v3
    s_lshl_b32 s66, s7, 3
    s_lshl_b32 s67, s9, s76
    s_add_u32 s66, s66, s67
    s_mul_i32 s66, s66, 55296
    s_mul_i32 s67, s70, 3456
    s_add_u32 s66, s66, s67
    v_lshl_add_u32 v56, v2, 11, s66
    s_mul_i32 s66, s9, 20480
    s_lshl_b32 s67, s6, 7
    s_add_u32 s66, s66, s67
    v_mul_u32_u24 v2, 81920, v2
    v_add_u32 v58, s66, v2
    v_and_b32 v2, 3, v0
    v_lshlrev_b32 v2, 14, v2
    v_add_u32 v2, 114688, v2
    v_subrev_u32 v3, 163840, v2
    v_min_u32 v2, v2, v3
    s_lshl_b32 s66, s9, 11
    s_lshl_b32 s66, s66, s76
    v_add_u32 v57, s66, v2
    v_add_u32 v2, 6, v0
    v_mul_u32_u24 v3, 6554, v2
    v_lshrrev_b32 v3, 16, v3
    v_mul_u32_u24 v3, 10, v3
    v_sub_u32 v2, v2, v3
    s_lshl_b32 s66, s9, 11
    s_add_u32 s66, s66, 32768
    v_lshl_add_u32 v59, v2, 13, s66
    s_mov_b32 s73, 0
    v_readlane_b32 s66, v58, 0
    v_readlane_b32 s67, v59, 0
    s_nop 2
L_wp1:
    s_mov_b32 m0, s67
    s_add_u32 s73, s73, 1
    buffer_load_dwordx4 v17, s[56:59], s66 offen lds
    buffer_load_dwordx4 v18, s[56:59], s66 offen offset:1024 lds
    v_readlane_b32 s66, v58, s73
    v_readlane_b32 s67, v59, s73
    s_cmp_lt_u32 s73, 10
    s_cbranch_scc1 L_wp1
    s_mov_b32 s74, 0
    v_lshlrev_b32 v50, 4, v0
    v_add_u32 v51, 53248, v50
    v_lshrrev_b32 v2, 4, v0
    v_lshlrev_b32 v52, 12, v2
    v_and_b32 v2, 15, v0
    v_lshl_add_u32 v52, v2, 4, v52
    v_lshlrev_b32 v53, 5, v2
    v_min_u32 v248, 35, v0
    v_lshl_add_u32 v248, s74, 2, v248
    v_subrev_u32 v3, 36, v248
    v_min_u32 v248, v248, v3
    s_lshl_b32 s91, s7, 8
    v_lshl_add_u32 v248, v248, 2, s91
    s_lshl_b32 s91, s6, 8
    s_add_u32 s91, s91, 4096
    v_and_b32 v249, 7, v0
    v_lshl_add_u32 v249, v249, 2, s91
    s_mul_i32 s91, s4, 10
    s_and_b32 s92, s7, 1
    s_lshl_b32 s92, s92, 2
    s_add_u32 s91, s91, s92
    v_and_b32 v2, 3, v0
    v_add_u32 v2, s91, v2
    v_lshrrev_b32 v3, 3, v2
    v_lshlrev_b32 v3, 8, v3
    v_and_b32 v2, 7, v2
    v_lshl_add_u32 v3, v2, 2, v3
    v_add_u32 v3, 4096, v3
    v_cmp_gt_u32 vcc, 32, v0
    s_mov_b32 s69, 0
    s_mov_b32 s72, 0
    s_mov_b32 s75, 0
    v_cndmask_b32 v249, v3, v249, vcc
    v_readlane_b32 s60, v56, 0
    v_readlane_b32 s61, v57, 0
    s_nop 3
    s_branch L_hl_loop
L_ssm:
    s_sub_u32 s77, s5, 22
    s_mul_i32 s6, s4, 10
    s_add_u32 s6, s6, s77
    s_lshl_b32 s6, s6, 3
    s_add_u32 s7, s6, s3
    v_lshlrev_b32 v4, 2, v0
    s_lshl_b32 s10, s7, 8
    s_lshl_b32 s11, s7, 1
    s_waitcnt lgkmcnt(0)
    s_mov_b32 s48, s18
    s_mov_b32 s49, s19
    s_mov_b32 s50, 0x28000
    s_mov_b32 s51, 0x00020000
    s_mov_b32 s64, s26
    s_mov_b32 s65, s27
    s_mov_b32 s66, 0x500
    s_mov_b32 s67, 0x00020000
    buffer_load_dword v6, v4, s[48:51], s10 offen
    buffer_load_ushort v10, v252, s[64:67], s11 offen
    s_mov_b32 s52, s20
    s_mov_b32 s53, s21
    s_mov_b32 s54, 0x28000
    s_mov_b32 s55, 0x00020000
    s_mov_b32 s56, s22
    s_mov_b32 s57, s23
    s_mov_b32 s58, 0x28000
    s_mov_b32 s59, 0x00020000
    s_mov_b32 s60, s24
    s_mov_b32 s61, s25
    s_mov_b32 s62, 0x28000
    s_mov_b32 s63, 0x00020000
    s_mov_b32 s44, s28
    s_mov_b32 s45, s29
    s_mov_b32 s46, 0x500
    s_mov_b32 s47, 0x00020000
    buffer_load_dword v7, v4, s[52:55], s10 offen
    buffer_load_dword v8, v4, s[56:59], s10 offen
    buffer_load_dword v9, v4, s[60:63], s10 offen
    buffer_load_ushort v11, v252, s[44:47], s11 offen
    s_barrier
    s_mov_b32 s72, s16
    s_mov_b32 s73, s17
    s_mov_b32 s74, 0x280000
    s_mov_b32 s75, 0x00020000
    s_mov_b32 s84, s40
    s_mov_b32 s85, s41
    s_mov_b32 s86, 0x100
    s_mov_b32 s87, 0x00020000
    s_add_u32 s96, s42, 0x990000
    s_addc_u32 s97, s43, 0
    s_mov_b32 s98, 0x2200
    s_mov_b32 s99, 0x00020000
    s_mul_i32 s9, s4, 160
    s_and_b32 s9, s9, 0xffffff80
    s_and_b32 s10, s3, 1
    s_lshl_b32 s10, s10, 7
    s_add_u32 s9, s9, s10
    s_lshl_b32 s10, s77, 2
    s_lshr_b32 s11, s3, 1
    s_add_u32 s10, s10, s11
    s_mul_i32 s10, s10, 66560
    s_add_u32 s9, s9, s10
    v_min_u32 v2, 51, v0
    v_mul_u32_u24 v2, 1280, v2
    s_mov_b32 s79, s9
    v_mul_u32_u24 v3, 5120, v0
    s_mul_i32 s78, s3, 327680
    s_lshl_b32 s9, s6, 1
    s_add_u32 s78, s78, s9
    s_sub_u32 s9, s78, 1280
    v_mov_b32 v5, s9
    s_mul_i32 s12, s3, 4592
    s_add_u32 s12, s12, 69648
    v_lshl_add_u32 v13, v0, 3, s12
    v_mov_b32 v14, 0
    v_mov_b32 v15, 0
    s_mov_b32 exec_hi, 0x0fffffff
    ds_write_b64 v13, v[14:15] offset:4096
    s_mov_b32 exec_hi, -1
    s_mul_i32 s13, s3, 8704
    s_mov_b32 m0, s13
    v_and_b32 v18, 15, v0
    v_lshrrev_b32 v19, 4, v0
    v_mul_u32_u24 v17, 544, v18
    v_lshl_add_u32 v17, v19, 4, v17
    v_add_u32 v17, s13, v17
    v_mov_b32 v16, 0x3c00
    ds_write_addtid_b32 v16
    ds_write_addtid_b32 v16 offset:256
    v_lshlrev_b32 v12, 4, v18
    v_sub_u32 v12, s12, v12
    v_lshlrev_b32 v27, 9, v19
    v_sub_u32 v24, v12, v27
    v_add_u32 v24, 1784, v24
    v_lshlrev_b32 v27, 8, v19
    v_sub_u32 v25, v12, v27
    v_add_u32 v25, 3060, v25
    v_lshrrev_b32 v27, 1, v19
    v_lshlrev_b32 v27, 8, v27
    v_sub_u32 v26, v12, v27
    v_and_b32 v27, 1, v19
    v_lshlrev_b32 v27, 3, v27
    v_sub_u32 v26, v26, v27
    s_mov_b32 s68, 0x3fb8aa3b
    s_mov_b32 s69, 0x32a57060
    s_mov_b32 s70, 0x3f317218
    s_mov_b32 s71, 0xffff0000
    s_waitcnt vmcnt(4)
    buffer_load_dword v248, v2, s[72:75], s79 offen
    v_lshlrev_b32 v10, 16, v10
    v_lshlrev_b32 v20, 16, v6
    v_and_b32 v21, s71, v6
    v_mul_f32 v28, s68, v10
    v_mul_f32 v30, s68, v20
    v_mul_f32 v32, s68, v21
    v_fma_f32 v29, v10, s68, -v28
    v_fma_f32 v31, v20, s68, -v30
    v_fma_f32 v33, v21, s68, -v32
    v_fma_f32 v29, v10, s69, v29
    v_fma_f32 v31, v20, s69, v31
    v_fma_f32 v33, v21, s69, v33
    v_exp_f32 v28, v28
    v_exp_f32 v30, v30
    v_exp_f32 v32, v32
    v_mul_f32 v29, s70, v29
    v_mul_f32 v31, s70, v31
    v_mul_f32 v33, s70, v33
    v_fma_f32 v10, v28, v29, v28
    v_fma_f32 v20, v30, v31, v30
    v_fma_f32 v21, v32, v33, v32
    v_cvt_pk_bf16_f32 v10, v10, v10
    v_cvt_pk_bf16_f32 v20, v20, v21
    v_lshlrev_b32 v10, 16, v10
    v_and_b32 v21, s71, v20
    v_lshlrev_b32 v20, 16, v20
    v_mul_f32 v20, v20, v10
    v_mul_f32 v21, v21, v10
    v_mul_f32 v20, 0xbfb8aa3b, v20
    v_mul_f32 v21, 0xbfb8aa3b, v21
    s_waitcnt vmcnt(1)
    v_lshlrev_b32 v22, 16, v7
    v_and_b32 v23, s71, v7
    v_mul_f32 v22, v22, v10
    v_mul_f32 v23, v23, v10
    v_mul_f32 v22, 0.15915494, v22
    v_mul_f32 v23, 0.15915494, v23
    v_mul_f32 v36, 0x43000000, v20
    v_mul_f32 v37, 0x43000000, v22
    v_mul_f32 v40, 0x43000000, v21
    v_mul_f32 v41, 0x43000000, v23
    v_rndne_f32 v30, v22
    v_rndne_f32 v34, v23
    v_rndne_f32 v38, v37
    v_rndne_f32 v42, v41
    v_exp_f32 v31, v20
    v_exp_f32 v35, v21
    v_exp_f32 v39, v36
    v_exp_f32 v43, v40
    v_sub_f32 v30, v22, v30
    v_sub_f32 v34, v23, v34
    v_sub_f32 v38, v37, v38
    v_sub_f32 v42, v41, v42
    v_cos_f32 v44, v30
    v_cos_f32 v46, v34
    v_cos_f32 v52, v38
    v_cos_f32 v54, v42
    v_sin_f32 v45, v30
    v_sin_f32 v47, v34
    v_sin_f32 v53, v38
    v_sin_f32 v55, v42
    v_mul_f32 v44, v44, v31
    v_mul_f32 v46, v46, v35
    v_mul_f32 v52, v52, v39
    v_mul_f32 v54, v54, v43
    v_mul_f32 v45, v45, v31
    v_mul_f32 v47, v47, v35
    v_mul_f32 v53, v53, v39
    v_mul_f32 v55, v55, v43
    v_and_b32 v28, 0x7fff7fff, v8
    v_and_b32 v29, 0x7fff7fff, v9
    v_pk_max_u16 v28, v28, v29
    v_lshlrev_b32 v29, 16, v28
    v_max_u32 v28, v28, v29
    v_cvt_pk_f16_f32 v60, v44, v45
    v_cvt_pk_f16_f32 v61, v46, v47
    v_cvt_pk_f16_f32 v74, v52, v53
    v_cvt_pk_f16_f32 v75, v54, v55
    v_pk_mul_f32 v[48:49], v[44:45], v[44:45] op_sel:[0,0] op_sel_hi:[1,0]
    v_pk_mul_f32 v[50:51], v[46:47], v[46:47] op_sel:[0,0] op_sel_hi:[1,0]
    v_pk_fma_f32 v[48:49], v[44:45], v[44:45], v[48:49] op_sel:[1,1,0] op_sel_hi:[0,1,1] neg_lo:[0,1,0]
    v_pk_fma_f32 v[50:51], v[46:47], v[46:47], v[50:51] op_sel:[1,1,0] op_sel_hi:[0,1,1] neg_lo:[0,1,0]
    v_pk_mul_f32 v[56:57], v[52:53], v[52:53] op_sel:[0,0] op_sel_hi:[1,0]
    v_pk_mul_f32 v[58:59], v[54:55], v[54:55] op_sel:[0,0] op_sel_hi:[1,0]
    v_pk_fma_f32 v[56:57], v[52:53], v[52:53], v[56:57] op_sel:[1,1,0] op_sel_hi:[0,1,1] neg_lo:[0,1,0]
    v_pk_fma_f32 v[58:59], v[54:55], v[54:55], v[58:59] op_sel:[1,1,0] op_sel_hi:[0,1,1] neg_lo:[0,1,0]
    v_max_u32_dpp v28, v28, v28 row_ror:8 row_mask:0xf bank_mask:0xf
    v_cvt_pk_f16_f32 v62, v48, v49
    v_cvt_pk_f16_f32 v63, v50, v51
    v_cvt_pk_f16_f32 v76, v56, v57
    v_cvt_pk_f16_f32 v77, v58, v59
    v_pk_mul_f32 v[44:45], v[48:49], v[48:49] op_sel:[0,0] op_sel_hi:[1,0]
    v_pk_mul_f32 v[46:47], v[50:51], v[50:51] op_sel:[0,0] op_sel_hi:[1,0]
    v_pk_fma_f32 v[44:45], v[48:49], v[48:49], v[44:45] op_sel:[1,1,0] op_sel_hi:[0,1,1] neg_lo:[0,1,0]
    v_pk_fma_f32 v[46:47], v[50:51], v[50:51], v[46:47] op_sel:[1,1,0] op_sel_hi:[0,1,1] neg_lo:[0,1,0]
    v_pk_mul_f32 v[52:53], v[56:57], v[56:57] op_sel:[0,0] op_sel_hi:[1,0]
    v_pk_mul_f32 v[54:55], v[58:59], v[58:59] op_sel:[0,0] op_sel_hi:[1,0]
    v_pk_fma_f32 v[52:53], v[56:57], v[56:57], v[52:53] op_sel:[1,1,0] op_sel_hi:[0,1,1] neg_lo:[0,1,0]
    v_pk_fma_f32 v[54:55], v[58:59], v[58:59], v[54:55] op_sel:[1,1,0] op_sel_hi:[0,1,1] neg_lo:[0,1,0]
    v_max_u32_dpp v28, v28, v28 row_ror:4 row_mask:0xf bank_mask:0xf
    v_cvt_pk_f16_f32 v64, v44, v45
    v_cvt_pk_f16_f32 v65, v46, v47
    v_cvt_pk_f16_f32 v78, v52, v53
    v_cvt_pk_f16_f32 v79, v54, v55
    v_pk_mul_f32 v[48:49], v[44:45], v[44:45] op_sel:[0,0] op_sel_hi:[1,0]
    v_pk_mul_f32 v[50:51], v[46:47], v[46:47] op_sel:[0,0] op_sel_hi:[1,0]
    v_pk_fma_f32 v[48:49], v[44:45], v[44:45], v[48:49] op_sel:[1,1,0] op_sel_hi:[0,1,1] neg_lo:[0,1,0]
    v_pk_fma_f32 v[50:51], v[46:47], v[46:47], v[50:51] op_sel:[1,1,0] op_sel_hi:[0,1,1] neg_lo:[0,1,0]
    v_pk_mul_f32 v[56:57], v[52:53], v[52:53] op_sel:[0,0] op_sel_hi:[1,0]
    v_pk_mul_f32 v[58:59], v[54:55], v[54:55] op_sel:[0,0] op_sel_hi:[1,0]
    v_pk_fma_f32 v[56:57], v[52:53], v[52:53], v[56:57] op_sel:[1,1,0] op_sel_hi:[0,1,1] neg_lo:[0,1,0]
    v_pk_fma_f32 v[58:59], v[54:55], v[54:55], v[58:59] op_sel:[1,1,0] op_sel_hi:[0,1,1] neg_lo:[0,1,0]
    v_max_u32_dpp v28, v28, v28 row_ror:2 row_mask:0xf bank_mask:0xf
    v_cvt_pk_f16_f32 v66, v48, v49
    v_cvt_pk_f16_f32 v67, v50, v51
    ds_write_addtid_b32 v66 offset:544
    ds_write_addtid_b32 v67 offset:800
    v_cvt_pk_f16_f32 v80, v56, v57
    v_cvt_pk_f16_f32 v81, v58, v59
    v_pk_mul_f32 v[44:45], v[48:49], v[48:49] op_sel:[0,0] op_sel_hi:[1,0]
    v_pk_mul_f32 v[46:47], v[50:51], v[50:51] op_sel:[0,0] op_sel_hi:[1,0]
    v_pk_fma_f32 v[44:45], v[48:49], v[48:49], v[44:45] op_sel:[1,1,0] op_sel_hi:[0,1,1] neg_lo:[0,1,0]
    v_pk_fma_f32 v[46:47], v[50:51], v[50:51], v[46:47] op_sel:[1,1,0] op_sel_hi:[0,1,1] neg_lo:[0,1,0]
    v_pk_mul_f32 v[52:53], v[56:57], v[56:57] op_sel:[0,0] op_sel_hi:[1,0]
    v_pk_mul_f32 v[54:55], v[58:59], v[58:59] op_sel:[0,0] op_sel_hi:[1,0]
    v_pk_fma_f32 v[52:53], v[56:57], v[56:57], v[52:53] op_sel:[1,1,0] op_sel_hi:[0,1,1] neg_lo:[0,1,0]
    v_pk_fma_f32 v[54:55], v[58:59], v[58:59], v[54:55] op_sel:[1,1,0] op_sel_hi:[0,1,1] neg_lo:[0,1,0]
    v_max_u32_dpp v28, v28, v28 row_ror:1 row_mask:0xf bank_mask:0xf
    v_cvt_pk_f16_f32 v68, v44, v45
    v_cvt_pk_f16_f32 v69, v46, v47
    ds_write_addtid_b32 v68 offset:1088
    ds_write_addtid_b32 v69 offset:1344
    v_cvt_pk_f16_f32 v82, v52, v53
    v_cvt_pk_f16_f32 v83, v54, v55
    v_pk_mul_f32 v[48:49], v[44:45], v[44:45] op_sel:[0,0] op_sel_hi:[1,0]
    v_pk_mul_f32 v[50:51], v[46:47], v[46:47] op_sel:[0,0] op_sel_hi:[1,0]
    v_pk_fma_f32 v[48:49], v[44:45], v[44:45], v[48:49] op_sel:[1,1,0] op_sel_hi:[0,1,1] neg_lo:[0,1,0]
    v_pk_fma_f32 v[50:51], v[46:47], v[46:47], v[50:51] op_sel:[1,1,0] op_sel_hi:[0,1,1] neg_lo:[0,1,0]
    v_readlane_b32 s90, v28, 0
    v_readlane_b32 s91, v28, 16
    v_readlane_b32 s92, v28, 32
    v_readlane_b32 s93, v28, 48
    v_cvt_pk_f16_f32 v70, v48, v49
    v_cvt_pk_f16_f32 v71, v50, v51
    ds_write_addtid_b32 v70 offset:2176
    ds_write_addtid_b32 v71 offset:2432
    v_pk_mul_f32 v[44:45], v[48:49], v[48:49] op_sel:[0,0] op_sel_hi:[1,0]
    v_pk_mul_f32 v[46:47], v[50:51], v[50:51] op_sel:[0,0] op_sel_hi:[1,0]
    v_pk_fma_f32 v[44:45], v[48:49], v[48:49], v[44:45] op_sel:[1,1,0] op_sel_hi:[0,1,1] neg_lo:[0,1,0]
    v_pk_fma_f32 v[46:47], v[50:51], v[50:51], v[46:47] op_sel:[1,1,0] op_sel_hi:[0,1,1] neg_lo:[0,1,0]
    s_max_u32 s90, s90, s91
    s_max_u32 s92, s92, s93
    s_max_u32 s90, s90, s92
    s_lshr_b32 s90, s90, 23
    s_max_u32 s90, s90, 1
    s_min_u32 s90, s90, 252
    s_sub_u32 s91, 254, s90
    s_lshl_b32 s91, s91, 23
    s_add_u32 s90, s90, 1
    s_lshl_b32 s90, s90, 23
    v_lshlrev_b32 v28, 16, v8
    v_lshlrev_b32 v29, 16, v9
    v_and_b32 v30, s71, v8
    v_and_b32 v31, s71, v9
    v_mul_f32 v28, s91, v28
    v_mul_f32 v29, s91, v29
    v_mul_f32 v30, s91, v30
    v_mul_f32 v31, s91, v31
    v_mul_f32 v10, s90, v10
    v_cvt_pk_f16_f32 v84, v28, -v29
    v_cvt_pk_f16_f32 v85, v30, -v31
    v_cvt_pk_f16_f32 v72, v44, v45
    v_cvt_pk_f16_f32 v73, v46, v47
    ds_write_addtid_b32 v72 offset:4352
    ds_write_addtid_b32 v73 offset:4608
    v_pk_mul_f16 v100, v66, v68 op_sel:[0,0] op_sel_hi:[1,0]
    v_pk_mul_f16 v101, v67, v69 op_sel:[0,0] op_sel_hi:[1,0]
    v_pk_mul_f16 v102, v66, v70 op_sel:[0,0] op_sel_hi:[1,0]
    v_pk_mul_f16 v103, v67, v71 op_sel:[0,0] op_sel_hi:[1,0]
    v_pk_fma_f16 v100, v66, v68, v100 op_sel:[1,1,0] op_sel_hi:[0,1,1] neg_lo:[0,1,0]
    v_pk_fma_f16 v101, v67, v69, v101 op_sel:[1,1,0] op_sel_hi:[0,1,1] neg_lo:[0,1,0]
    v_pk_fma_f16 v102, v66, v70, v102 op_sel:[1,1,0] op_sel_hi:[0,1,1] neg_lo:[0,1,0]
    v_pk_fma_f16 v103, v67, v71, v103 op_sel:[1,1,0] op_sel_hi:[0,1,1] neg_lo:[0,1,0]
    ds_write_addtid_b32 v100 offset:1632
    ds_write_addtid_b32 v101 offset:1888
    ds_write_addtid_b32 v102 offset:2720
    ds_write_addtid_b32 v103 offset:2976
    v_pk_mul_f16 v104, v68, v70 op_sel:[0,0] op_sel_hi:[1,0]
    v_pk_mul_f16 v105, v69, v71 op_sel:[0,0] op_sel_hi:[1,0]
    v_pk_mul_f16 v106, v100, v70 op_sel:[0,0] op_sel_hi:[1,0]
    v_pk_mul_f16 v107, v101, v71 op_sel:[0,0] op_sel_hi:[1,0]
    v_pk_fma_f16 v104, v68, v70, v104 op_sel:[1,1,0] op_sel_hi:[0,1,1] neg_lo:[0,1,0]
    v_pk_fma_f16 v105, v69, v71, v105 op_sel:[1,1,0] op_sel_hi:[0,1,1] neg_lo:[0,1,0]
    v_pk_fma_f16 v106, v100, v70, v106 op_sel:[1,1,0] op_sel_hi:[0,1,1] neg_lo:[0,1,0]
    v_pk_fma_f16 v107, v101, v71, v107 op_sel:[1,1,0] op_sel_hi:[0,1,1] neg_lo:[0,1,0]
    ds_write_addtid_b32 v104 offset:3264
    ds_write_addtid_b32 v105 offset:3520
    ds_write_addtid_b32 v106 offset:3808
    ds_write_addtid_b32 v107 offset:4064
    v_pk_mul_f16 v30, v66, v72 op_sel:[0,0] op_sel_hi:[1,0]
    v_pk_mul_f16 v31, v67, v73 op_sel:[0,0] op_sel_hi:[1,0]
    v_pk_mul_f16 v32, v68, v72 op_sel:[0,0] op_sel_hi:[1,0]
    v_pk_mul_f16 v33, v69, v73 op_sel:[0,0] op_sel_hi:[1,0]
    v_pk_fma_f16 v30, v66, v72, v30 op_sel:[1,1,0] op_sel_hi:[0,1,1] neg_lo:[0,1,0]
    v_pk_fma_f16 v31, v67, v73, v31 op_sel:[1,1,0] op_sel_hi:[0,1,1] neg_lo:[0,1,0]
    v_pk_fma_f16 v32, v68, v72, v32 op_sel:[1,1,0] op_sel_hi:[0,1,1] neg_lo:[0,1,0]
    v_pk_fma_f16 v33, v69, v73, v33 op_sel:[1,1,0] op_sel_hi:[0,1,1] neg_lo:[0,1,0]
    ds_write_addtid_b32 v30 offset:4896
    ds_write_addtid_b32 v31 offset:5152
    ds_write_addtid_b32 v32 offset:5440
    ds_write_addtid_b32 v33 offset:5696
    v_pk_mul_f16 v34, v100, v72 op_sel:[0,0] op_sel_hi:[1,0]
    v_pk_mul_f16 v35, v101, v73 op_sel:[0,0] op_sel_hi:[1,0]
    v_pk_mul_f16 v36, v70, v72 op_sel:[0,0] op_sel_hi:[1,0]
    v_pk_mul_f16 v37, v71, v73 op_sel:[0,0] op_sel_hi:[1,0]
    v_pk_fma_f16 v34, v100, v72, v34 op_sel:[1,1,0] op_sel_hi:[0,1,1] neg_lo:[0,1,0]
    v_pk_fma_f16 v35, v101, v73, v35 op_sel:[1,1,0] op_sel_hi:[0,1,1] neg_lo:[0,1,0]
    v_pk_fma_f16 v36, v70, v72, v36 op_sel:[1,1,0] op_sel_hi:[0,1,1] neg_lo:[0,1,0]
    v_pk_fma_f16 v37, v71, v73, v37 op_sel:[1,1,0] op_sel_hi:[0,1,1] neg_lo:[0,1,0]
    ds_write_addtid_b32 v34 offset:5984
    ds_write_addtid_b32 v35 offset:6240
    ds_write_addtid_b32 v36 offset:6528
    ds_write_addtid_b32 v37 offset:6784
    v_pk_mul_f16 v38, v102, v72 op_sel:[0,0] op_sel_hi:[1,0]
    v_pk_mul_f16 v39, v103, v73 op_sel:[0,0] op_sel_hi:[1,0]
    v_pk_mul_f16 v40, v104, v72 op_sel:[0,0] op_sel_hi:[1,0]
    v_pk_mul_f16 v41, v105, v73 op_sel:[0,0] op_sel_hi:[1,0]
    v_pk_fma_f16 v38, v102, v72, v38 op_sel:[1,1,0] op_sel_hi:[0,1,1] neg_lo:[0,1,0]
    v_pk_fma_f16 v39, v103, v73, v39 op_sel:[1,1,0] op_sel_hi:[0,1,1] neg_lo:[0,1,0]
    v_pk_fma_f16 v40, v104, v72, v40 op_sel:[1,1,0] op_sel_hi:[0,1,1] neg_lo:[0,1,0]
    v_pk_fma_f16 v41, v105, v73, v41 op_sel:[1,1,0] op_sel_hi:[0,1,1] neg_lo:[0,1,0]
    ds_write_addtid_b32 v38 offset:7072
    ds_write_addtid_b32 v39 offset:7328
    ds_write_addtid_b32 v40 offset:7616
    ds_write_addtid_b32 v41 offset:7872
    v_pk_mul_f16 v42, v106, v72 op_sel:[0,0] op_sel_hi:[1,0]
    v_pk_mul_f16 v43, v107, v73 op_sel:[0,0] op_sel_hi:[1,0]
    v_pk_fma_f16 v42, v106, v72, v42 op_sel:[1,1,0] op_sel_hi:[0,1,1] neg_lo:[0,1,0]
    v_pk_fma_f16 v43, v107, v73, v43 op_sel:[1,1,0] op_sel_hi:[0,1,1] neg_lo:[0,1,0]
    ds_write_addtid_b32 v42 offset:8160
    ds_write_addtid_b32 v43 offset:8416
    ds_read_b128 v[152:155], v17 offset:0
    ds_read_b128 v[156:159], v17 offset:64
    ds_read_b128 v[160:163], v17 offset:128
    ds_read_b128 v[164:167], v17 offset:192
    ds_read_b128 v[168:171], v17 offset:256
    ds_read_b128 v[172:175], v17 offset:320
    ds_read_b128 v[176:179], v17 offset:384
    ds_read_b128 v[180:183], v17 offset:448
    buffer_load_dwordx4 v[228:231], v3, s[72:75], s78 offen offset:0
    v_pk_mul_f16 v86, v84, v60 op_sel:[0,0] op_sel_hi:[1,0]
    v_pk_mul_f16 v87, v85, v61 op_sel:[0,0] op_sel_hi:[1,0]
    v_pk_mul_f16 v88, v84, v62 op_sel:[0,0] op_sel_hi:[1,0]
    v_pk_mul_f16 v89, v85, v63 op_sel:[0,0] op_sel_hi:[1,0]
    v_pk_fma_f16 v86, v84, v60, v86 op_sel:[1,1,0] op_sel_hi:[0,1,1] neg_hi:[0,1,0]
    v_pk_fma_f16 v87, v85, v61, v87 op_sel:[1,1,0] op_sel_hi:[0,1,1] neg_hi:[0,1,0]
    v_pk_fma_f16 v88, v84, v62, v88 op_sel:[1,1,0] op_sel_hi:[0,1,1] neg_hi:[0,1,0]
    v_pk_fma_f16 v89, v85, v63, v89 op_sel:[1,1,0] op_sel_hi:[0,1,1] neg_hi:[0,1,0]
    s_waitcnt lgkmcnt(0)
    ds_write_addtid_b32 v86 offset:544
    ds_write_addtid_b32 v87 offset:800
    ds_write_addtid_b32 v88 offset:1088
    ds_write_addtid_b32 v89 offset:1344
    v_pk_mul_f16 v90, v86, v62 op_sel:[0,0] op_sel_hi:[1,0]
    v_pk_mul_f16 v91, v87, v63 op_sel:[0,0] op_sel_hi:[1,0]
    v_pk_mul_f16 v92, v84, v64 op_sel:[0,0] op_sel_hi:[1,0]
    v_pk_mul_f16 v93, v85, v65 op_sel:[0,0] op_sel_hi:[1,0]
    v_pk_fma_f16 v90, v86, v62, v90 op_sel:[1,1,0] op_sel_hi:[0,1,1] neg_hi:[0,1,0]
    v_pk_fma_f16 v91, v87, v63, v91 op_sel:[1,1,0] op_sel_hi:[0,1,1] neg_hi:[0,1,0]
    v_pk_fma_f16 v92, v84, v64, v92 op_sel:[1,1,0] op_sel_hi:[0,1,1] neg_hi:[0,1,0]
    v_pk_fma_f16 v93, v85, v65, v93 op_sel:[1,1,0] op_sel_hi:[0,1,1] neg_hi:[0,1,0]
    ds_write_addtid_b32 v90 offset:1632
    ds_write_addtid_b32 v91 offset:1888
    ds_write_addtid_b32 v92 offset:2176
    ds_write_addtid_b32 v93 offset:2432
    v_pk_mul_f16 v94, v86, v64 op_sel:[0,0] op_sel_hi:[1,0]
    v_pk_mul_f16 v95, v87, v65 op_sel:[0,0] op_sel_hi:[1,0]
    v_pk_mul_f16 v96, v88, v64 op_sel:[0,0] op_sel_hi:[1,0]
    v_pk_mul_f16 v97, v89, v65 op_sel:[0,0] op_sel_hi:[1,0]
    v_pk_fma_f16 v94, v86, v64, v94 op_sel:[1,1,0] op_sel_hi:[0,1,1] neg_hi:[0,1,0]
    v_pk_fma_f16 v95, v87, v65, v95 op_sel:[1,1,0] op_sel_hi:[0,1,1] neg_hi:[0,1,0]
    v_pk_fma_f16 v96, v88, v64, v96 op_sel:[1,1,0] op_sel_hi:[0,1,1] neg_hi:[0,1,0]
    v_pk_fma_f16 v97, v89, v65, v97 op_sel:[1,1,0] op_sel_hi:[0,1,1] neg_hi:[0,1,0]
    ds_write_addtid_b32 v94 offset:2720
    ds_write_addtid_b32 v95 offset:2976
    ds_write_addtid_b32 v96 offset:3264
    ds_write_addtid_b32 v97 offset:3520
    v_pk_mul_f16 v98, v90, v64 op_sel:[0,0] op_sel_hi:[1,0]
    v_pk_mul_f16 v99, v91, v65 op_sel:[0,0] op_sel_hi:[1,0]
    v_pk_mul_f16 v100, v84, v74 op_sel:[0,0] op_sel_hi:[1,0]
    v_pk_mul_f16 v101, v85, v75 op_sel:[0,0] op_sel_hi:[1,0]
    v_pk_fma_f16 v98, v90, v64, v98 op_sel:[1,1,0] op_sel_hi:[0,1,1] neg_hi:[0,1,0]
    v_pk_fma_f16 v99, v91, v65, v99 op_sel:[1,1,0] op_sel_hi:[0,1,1] neg_hi:[0,1,0]
    v_pk_fma_f16 v100, v84, v74, v100 op_sel:[1,1,0] op_sel_hi:[0,1,1] neg_hi:[0,1,0]
    v_pk_fma_f16 v101, v85, v75, v101 op_sel:[1,1,0] op_sel_hi:[0,1,1] neg_hi:[0,1,0]
    ds_write_addtid_b32 v98 offset:3808
    ds_write_addtid_b32 v99 offset:4064
    ds_write_addtid_b32 v100 offset:4352
    ds_write_addtid_b32 v101 offset:4608
    ds_write_addtid_b32 v84 offset:0
    ds_write_addtid_b32 v85 offset:256
    buffer_load_dwordx4 v[232:235], v3, s[72:75], s78 offen offset:1280
    v_pk_mul_f16 v102, v86, v74 op_sel:[0,0] op_sel_hi:[1,0]
    v_pk_mul_f16 v103, v87, v75 op_sel:[0,0] op_sel_hi:[1,0]
    v_pk_mul_f16 v104, v88, v74 op_sel:[0,0] op_sel_hi:[1,0]
    v_pk_mul_f16 v105, v89, v75 op_sel:[0,0] op_sel_hi:[1,0]
    v_pk_fma_f16 v102, v86, v74, v102 op_sel:[1,1,0] op_sel_hi:[0,1,1] neg_hi:[0,1,0]
    v_pk_fma_f16 v103, v87, v75, v103 op_sel:[1,1,0] op_sel_hi:[0,1,1] neg_hi:[0,1,0]
    v_pk_fma_f16 v104, v88, v74, v104 op_sel:[1,1,0] op_sel_hi:[0,1,1] neg_hi:[0,1,0]
    v_pk_fma_f16 v105, v89, v75, v105 op_sel:[1,1,0] op_sel_hi:[0,1,1] neg_hi:[0,1,0]
    ds_write_addtid_b32 v102 offset:4896
    ds_write_addtid_b32 v103 offset:5152
    ds_write_addtid_b32 v104 offset:5440
    ds_write_addtid_b32 v105 offset:5696
    v_pk_mul_f16 v106, v90, v74 op_sel:[0,0] op_sel_hi:[1,0]
    v_pk_mul_f16 v107, v91, v75 op_sel:[0,0] op_sel_hi:[1,0]
    v_pk_mul_f16 v108, v92, v74 op_sel:[0,0] op_sel_hi:[1,0]
    v_pk_mul_f16 v109, v93, v75 op_sel:[0,0] op_sel_hi:[1,0]
    v_pk_fma_f16 v106, v90, v74, v106 op_sel:[1,1,0] op_sel_hi:[0,1,1] neg_hi:[0,1,0]
    v_pk_fma_f16 v107, v91, v75, v107 op_sel:[1,1,0] op_sel_hi:[0,1,1] neg_hi:[0,1,0]
    v_pk_fma_f16 v108, v92, v74, v108 op_sel:[1,1,0] op_sel_hi:[0,1,1] neg_hi:[0,1,0]
    v_pk_fma_f16 v109, v93, v75, v109 op_sel:[1,1,0] op_sel_hi:[0,1,1] neg_hi:[0,1,0]
    ds_write_addtid_b32 v106 offset:5984
    ds_write_addtid_b32 v107 offset:6240
    ds_write_addtid_b32 v108 offset:6528
    ds_write_addtid_b32 v109 offset:6784
    v_pk_mul_f16 v110, v94, v74 op_sel:[0,0] op_sel_hi:[1,0]
    v_pk_mul_f16 v111, v95, v75 op_sel:[0,0] op_sel_hi:[1,0]
    v_pk_mul_f16 v112, v96, v74 op_sel:[0,0] op_sel_hi:[1,0]
    v_pk_mul_f16 v113, v97, v75 op_sel:[0,0] op_sel_hi:[1,0]
    v_pk_fma_f16 v110, v94, v74, v110 op_sel:[1,1,0] op_sel_hi:[0,1,1] neg_hi:[0,1,0]
    v_pk_fma_f16 v111, v95, v75, v111 op_sel:[1,1,0] op_sel_hi:[0,1,1] neg_hi:[0,1,0]
    v_pk_fma_f16 v112, v96, v74, v112 op_sel:[1,1,0] op_sel_hi:[0,1,1] neg_hi:[0,1,0]
    v_pk_fma_f16 v113, v97, v75, v113 op_sel:[1,1,0] op_sel_hi:[0,1,1] neg_hi:[0,1,0]
    ds_write_addtid_b32 v110 offset:7072
    ds_write_addtid_b32 v111 offset:7328
    ds_write_addtid_b32 v112 offset:7616
    ds_write_addtid_b32 v113 offset:7872
    v_pk_mul_f16 v114, v98, v74 op_sel:[0,0] op_sel_hi:[1,0]
    v_pk_mul_f16 v115, v99, v75 op_sel:[0,0] op_sel_hi:[1,0]
    v_pk_fma_f16 v114, v98, v74, v114 op_sel:[1,1,0] op_sel_hi:[0,1,1] neg_hi:[0,1,0]
    v_pk_fma_f16 v115, v99, v75, v115 op_sel:[1,1,0] op_sel_hi:[0,1,1] neg_hi:[0,1,0]
    ds_write_addtid_b32 v114 offset:8160
    ds_write_addtid_b32 v115 offset:8416
    ds_read_b128 v[184:187], v17 offset:0
    ds_read_b128 v[188:191], v17 offset:64
    ds_read_b128 v[192:195], v17 offset:128
    ds_read_b128 v[196:199], v17 offset:192
    ds_read_b128 v[200:203], v17 offset:256
    ds_read_b128 v[204:207], v17 offset:320
    ds_read_b128 v[208:211], v17 offset:384
    ds_read_b128 v[212:215], v17 offset:448
    buffer_load_dwordx4 v[236:239], v3, s[72:75], s78 offen offset:2560
    v_pk_mul_f16 v116, v84, v76 op_sel:[0,0] op_sel_hi:[1,0]
    v_pk_mul_f16 v117, v85, v77 op_sel:[0,0] op_sel_hi:[1,0]
    v_pk_mul_f16 v118, v88, v76 op_sel:[0,0] op_sel_hi:[1,0]
    v_pk_mul_f16 v119, v89, v77 op_sel:[0,0] op_sel_hi:[1,0]
    v_pk_fma_f16 v116, v84, v76, v116 op_sel:[1,1,0] op_sel_hi:[0,1,1] neg_hi:[0,1,0]
    v_pk_fma_f16 v117, v85, v77, v117 op_sel:[1,1,0] op_sel_hi:[0,1,1] neg_hi:[0,1,0]
    v_pk_fma_f16 v118, v88, v76, v118 op_sel:[1,1,0] op_sel_hi:[0,1,1] neg_hi:[0,1,0]
    v_pk_fma_f16 v119, v89, v77, v119 op_sel:[1,1,0] op_sel_hi:[0,1,1] neg_hi:[0,1,0]
    s_waitcnt lgkmcnt(0)
    ds_write_addtid_b32 v116 offset:0
    ds_write_addtid_b32 v117 offset:256
    ds_write_addtid_b32 v118 offset:544
    ds_write_addtid_b32 v119 offset:800
    v_mfma_f32_16x16x32_f16 v[216:219], v[184:187], v[152:155], 0
    v_mfma_f32_16x16x32_f16 v[216:219], v[188:191], v[156:159], v[216:219]
    v_mfma_f32_16x16x32_f16 v[216:219], v[192:195], v[160:163], v[216:219]
    v_mfma_f32_16x16x32_f16 v[216:219], v[196:199], v[164:167], v[216:219]
    v_mfma_f32_16x16x32_f16 v[216:219], v[200:203], v[168:171], v[216:219]
    v_mfma_f32_16x16x32_f16 v[216:219], v[204:207], v[172:175], v[216:219]
    v_mfma_f32_16x16x32_f16 v[216:219], v[208:211], v[176:179], v[216:219]
    v_mfma_f32_16x16x32_f16 v[216:219], v[212:215], v[180:183], v[216:219]
    v_pk_mul_f16 v120, v92, v76 op_sel:[0,0] op_sel_hi:[1,0]
    v_pk_mul_f16 v121, v93, v77 op_sel:[0,0] op_sel_hi:[1,0]
    v_pk_mul_f16 v122, v96, v76 op_sel:[0,0] op_sel_hi:[1,0]
    v_pk_mul_f16 v123, v97, v77 op_sel:[0,0] op_sel_hi:[1,0]
    v_pk_fma_f16 v120, v92, v76, v120 op_sel:[1,1,0] op_sel_hi:[0,1,1] neg_hi:[0,1,0]
    v_pk_fma_f16 v121, v93, v77, v121 op_sel:[1,1,0] op_sel_hi:[0,1,1] neg_hi:[0,1,0]
    v_pk_fma_f16 v122, v96, v76, v122 op_sel:[1,1,0] op_sel_hi:[0,1,1] neg_hi:[0,1,0]
    v_pk_fma_f16 v123, v97, v77, v123 op_sel:[1,1,0] op_sel_hi:[0,1,1] neg_hi:[0,1,0]
    ds_write_addtid_b32 v120 offset:1088
    ds_write_addtid_b32 v121 offset:1344
    ds_write_addtid_b32 v122 offset:1632
    ds_write_addtid_b32 v123 offset:1888
    v_pk_mul_f16 v124, v100, v76 op_sel:[0,0] op_sel_hi:[1,0]
    v_pk_mul_f16 v125, v101, v77 op_sel:[0,0] op_sel_hi:[1,0]
    v_pk_mul_f16 v126, v104, v76 op_sel:[0,0] op_sel_hi:[1,0]
    v_pk_mul_f16 v127, v105, v77 op_sel:[0,0] op_sel_hi:[1,0]
    v_pk_fma_f16 v124, v100, v76, v124 op_sel:[1,1,0] op_sel_hi:[0,1,1] neg_hi:[0,1,0]
    v_pk_fma_f16 v125, v101, v77, v125 op_sel:[1,1,0] op_sel_hi:[0,1,1] neg_hi:[0,1,0]
    v_pk_fma_f16 v126, v104, v76, v126 op_sel:[1,1,0] op_sel_hi:[0,1,1] neg_hi:[0,1,0]
    v_pk_fma_f16 v127, v105, v77, v127 op_sel:[1,1,0] op_sel_hi:[0,1,1] neg_hi:[0,1,0]
    ds_write_addtid_b32 v124 offset:2176
    ds_write_addtid_b32 v125 offset:2432
    ds_write_addtid_b32 v126 offset:2720
    ds_write_addtid_b32 v127 offset:2976
    v_pk_mul_f16 v128, v108, v76 op_sel:[0,0] op_sel_hi:[1,0]
    v_pk_mul_f16 v129, v109, v77 op_sel:[0,0] op_sel_hi:[1,0]
    v_pk_mul_f16 v130, v112, v76 op_sel:[0,0] op_sel_hi:[1,0]
    v_pk_mul_f16 v131, v113, v77 op_sel:[0,0] op_sel_hi:[1,0]
    v_pk_fma_f16 v128, v108, v76, v128 op_sel:[1,1,0] op_sel_hi:[0,1,1] neg_hi:[0,1,0]
    v_pk_fma_f16 v129, v109, v77, v129 op_sel:[1,1,0] op_sel_hi:[0,1,1] neg_hi:[0,1,0]
    v_pk_fma_f16 v130, v112, v76, v130 op_sel:[1,1,0] op_sel_hi:[0,1,1] neg_hi:[0,1,0]
    v_pk_fma_f16 v131, v113, v77, v131 op_sel:[1,1,0] op_sel_hi:[0,1,1] neg_hi:[0,1,0]
    ds_write_addtid_b32 v128 offset:3264
    ds_write_addtid_b32 v129 offset:3520
    ds_write_addtid_b32 v130 offset:3808
    ds_write_addtid_b32 v131 offset:4064
    v_pk_mul_f16 v28, v84, v82 op_sel:[0,0] op_sel_hi:[1,0]
    v_pk_mul_f16 v29, v85, v83 op_sel:[0,0] op_sel_hi:[1,0]
    v_pk_fma_f16 v28, v84, v82, v28 op_sel:[1,1,0] op_sel_hi:[0,1,1] neg_hi:[0,1,0]
    v_pk_fma_f16 v29, v85, v83, v29 op_sel:[1,1,0] op_sel_hi:[0,1,1] neg_hi:[0,1,0]
    ds_write_addtid_b32 v28 offset:4352
    ds_write_addtid_b32 v29 offset:4608
    ds_read_b128 v[184:187], v17 offset:0
    ds_read_b128 v[188:191], v17 offset:64
    ds_read_b128 v[192:195], v17 offset:128
    ds_read_b128 v[196:199], v17 offset:192
    ds_read_b128 v[200:203], v17 offset:256
    ds_read_b128 v[204:207], v17 offset:320
    ds_read_b128 v[208:211], v17 offset:384
    ds_read_b128 v[212:215], v17 offset:448
    buffer_load_dwordx4 v[240:243], v3, s[72:75], s78 offen offset:3840
    s_mov_b64 exec, 1
    buffer_load_dwordx4 v[244:247], v5, s[72:75], 0 offen
    s_mov_b64 exec, -1
    s_cmp_eq_u32 s3, 0
    s_cbranch_scc0 L_kg_nj
    buffer_load_dword v251, v252, s[84:87], 0 offen sc1
L_kg_nj:
    v_pk_mul_f16 v132, v84, v78 op_sel:[0,0] op_sel_hi:[1,0]
    v_pk_mul_f16 v133, v85, v79 op_sel:[0,0] op_sel_hi:[1,0]
    v_pk_mul_f16 v134, v92, v78 op_sel:[0,0] op_sel_hi:[1,0]
    v_pk_mul_f16 v135, v93, v79 op_sel:[0,0] op_sel_hi:[1,0]
    v_pk_fma_f16 v132, v84, v78, v132 op_sel:[1,1,0] op_sel_hi:[0,1,1] neg_hi:[0,1,0]
    v_pk_fma_f16 v133, v85, v79, v133 op_sel:[1,1,0] op_sel_hi:[0,1,1] neg_hi:[0,1,0]
    v_pk_fma_f16 v134, v92, v78, v134 op_sel:[1,1,0] op_sel_hi:[0,1,1] neg_hi:[0,1,0]
    v_pk_fma_f16 v135, v93, v79, v135 op_sel:[1,1,0] op_sel_hi:[0,1,1] neg_hi:[0,1,0]
    s_waitcnt lgkmcnt(0)
    ds_write_addtid_b32 v132 offset:0
    ds_write_addtid_b32 v133 offset:256
    ds_write_addtid_b32 v134 offset:544
    ds_write_addtid_b32 v135 offset:800
    v_mfma_f32_16x16x32_f16 v[220:223], v[184:187], v[152:155], 0
    v_mfma_f32_16x16x32_f16 v[220:223], v[188:191], v[156:159], v[220:223]
    v_mfma_f32_16x16x32_f16 v[220:223], v[192:195], v[160:163], v[220:223]
    v_mfma_f32_16x16x32_f16 v[220:223], v[196:199], v[164:167], v[220:223]
    v_mfma_f32_16x16x32_f16 v[220:223], v[200:203], v[168:171], v[220:223]
    v_mfma_f32_16x16x32_f16 v[220:223], v[204:207], v[172:175], v[220:223]
    v_mfma_f32_16x16x32_f16 v[220:223], v[208:211], v[176:179], v[220:223]
    v_mfma_f32_16x16x32_f16 v[220:223], v[212:215], v[180:183], v[220:223]
    v_pk_mul_f16 v136, v100, v78 op_sel:[0,0] op_sel_hi:[1,0]
    v_pk_mul_f16 v137, v101, v79 op_sel:[0,0] op_sel_hi:[1,0]
    v_pk_mul_f16 v138, v108, v78 op_sel:[0,0] op_sel_hi:[1,0]
    v_pk_mul_f16 v139, v109, v79 op_sel:[0,0] op_sel_hi:[1,0]
    v_pk_fma_f16 v136, v100, v78, v136 op_sel:[1,1,0] op_sel_hi:[0,1,1] neg_hi:[0,1,0]
    v_pk_fma_f16 v137, v101, v79, v137 op_sel:[1,1,0] op_sel_hi:[0,1,1] neg_hi:[0,1,0]
    v_pk_fma_f16 v138, v108, v78, v138 op_sel:[1,1,0] op_sel_hi:[0,1,1] neg_hi:[0,1,0]
    v_pk_fma_f16 v139, v109, v79, v139 op_sel:[1,1,0] op_sel_hi:[0,1,1] neg_hi:[0,1,0]
    ds_write_addtid_b32 v136 offset:2176
    ds_write_addtid_b32 v137 offset:2432
    ds_write_addtid_b32 v138 offset:2720
    ds_write_addtid_b32 v139 offset:2976
    v_pk_mul_f16 v140, v116, v78 op_sel:[0,0] op_sel_hi:[1,0]
    v_pk_mul_f16 v141, v117, v79 op_sel:[0,0] op_sel_hi:[1,0]
    v_pk_mul_f16 v142, v120, v78 op_sel:[0,0] op_sel_hi:[1,0]
    v_pk_mul_f16 v143, v121, v79 op_sel:[0,0] op_sel_hi:[1,0]
    v_pk_fma_f16 v140, v116, v78, v140 op_sel:[1,1,0] op_sel_hi:[0,1,1] neg_hi:[0,1,0]
    v_pk_fma_f16 v141, v117, v79, v141 op_sel:[1,1,0] op_sel_hi:[0,1,1] neg_hi:[0,1,0]
    v_pk_fma_f16 v142, v120, v78, v142 op_sel:[1,1,0] op_sel_hi:[0,1,1] neg_hi:[0,1,0]
    v_pk_fma_f16 v143, v121, v79, v143 op_sel:[1,1,0] op_sel_hi:[0,1,1] neg_hi:[0,1,0]
    ds_write_addtid_b32 v140 offset:4352
    ds_write_addtid_b32 v141 offset:4608
    ds_write_addtid_b32 v142 offset:4896
    ds_write_addtid_b32 v143 offset:5152
    v_pk_mul_f16 v144, v124, v78 op_sel:[0,0] op_sel_hi:[1,0]
    v_pk_mul_f16 v145, v125, v79 op_sel:[0,0] op_sel_hi:[1,0]
    v_pk_mul_f16 v146, v128, v78 op_sel:[0,0] op_sel_hi:[1,0]
    v_pk_mul_f16 v147, v129, v79 op_sel:[0,0] op_sel_hi:[1,0]
    v_pk_fma_f16 v144, v124, v78, v144 op_sel:[1,1,0] op_sel_hi:[0,1,1] neg_hi:[0,1,0]
    v_pk_fma_f16 v145, v125, v79, v145 op_sel:[1,1,0] op_sel_hi:[0,1,1] neg_hi:[0,1,0]
    v_pk_fma_f16 v146, v128, v78, v146 op_sel:[1,1,0] op_sel_hi:[0,1,1] neg_hi:[0,1,0]
    v_pk_fma_f16 v147, v129, v79, v147 op_sel:[1,1,0] op_sel_hi:[0,1,1] neg_hi:[0,1,0]
    ds_write_addtid_b32 v144 offset:6528
    ds_write_addtid_b32 v145 offset:6784
    ds_write_addtid_b32 v146 offset:7072
    ds_write_addtid_b32 v147 offset:7328
    v_pk_mul_f16 v28, v84, v80 op_sel:[0,0] op_sel_hi:[1,0]
    v_pk_mul_f16 v29, v85, v81 op_sel:[0,0] op_sel_hi:[1,0]
    v_pk_mul_f16 v30, v100, v80 op_sel:[0,0] op_sel_hi:[1,0]
    v_pk_mul_f16 v31, v101, v81 op_sel:[0,0] op_sel_hi:[1,0]
    v_pk_fma_f16 v28, v84, v80, v28 op_sel:[1,1,0] op_sel_hi:[0,1,1] neg_hi:[0,1,0]
    v_pk_fma_f16 v29, v85, v81, v29 op_sel:[1,1,0] op_sel_hi:[0,1,1] neg_hi:[0,1,0]
    v_pk_fma_f16 v30, v100, v80, v30 op_sel:[1,1,0] op_sel_hi:[0,1,1] neg_hi:[0,1,0]
    v_pk_fma_f16 v31, v101, v81, v31 op_sel:[1,1,0] op_sel_hi:[0,1,1] neg_hi:[0,1,0]
    ds_write_addtid_b32 v28 offset:1088
    ds_write_addtid_b32 v29 offset:1344
    ds_write_addtid_b32 v30 offset:1632
    ds_write_addtid_b32 v31 offset:1888
    v_pk_mul_f16 v32, v116, v80 op_sel:[0,0] op_sel_hi:[1,0]
    v_pk_mul_f16 v33, v117, v81 op_sel:[0,0] op_sel_hi:[1,0]
    v_pk_mul_f16 v34, v124, v80 op_sel:[0,0] op_sel_hi:[1,0]
    v_pk_mul_f16 v35, v125, v81 op_sel:[0,0] op_sel_hi:[1,0]
    v_pk_fma_f16 v32, v116, v80, v32 op_sel:[1,1,0] op_sel_hi:[0,1,1] neg_hi:[0,1,0]
    v_pk_fma_f16 v33, v117, v81, v33 op_sel:[1,1,0] op_sel_hi:[0,1,1] neg_hi:[0,1,0]
    v_pk_fma_f16 v34, v124, v80, v34 op_sel:[1,1,0] op_sel_hi:[0,1,1] neg_hi:[0,1,0]
    v_pk_fma_f16 v35, v125, v81, v35 op_sel:[1,1,0] op_sel_hi:[0,1,1] neg_hi:[0,1,0]
    ds_write_addtid_b32 v32 offset:3264
    ds_write_addtid_b32 v33 offset:3520
    ds_write_addtid_b32 v34 offset:3808
    ds_write_addtid_b32 v35 offset:4064
    v_pk_mul_f16 v36, v132, v80 op_sel:[0,0] op_sel_hi:[1,0]
    v_pk_mul_f16 v37, v133, v81 op_sel:[0,0] op_sel_hi:[1,0]
    v_pk_mul_f16 v38, v136, v80 op_sel:[0,0] op_sel_hi:[1,0]
    v_pk_mul_f16 v39, v137, v81 op_sel:[0,0] op_sel_hi:[1,0]
    v_pk_fma_f16 v36, v132, v80, v36 op_sel:[1,1,0] op_sel_hi:[0,1,1] neg_hi:[0,1,0]
    v_pk_fma_f16 v37, v133, v81, v37 op_sel:[1,1,0] op_sel_hi:[0,1,1] neg_hi:[0,1,0]
    v_pk_fma_f16 v38, v136, v80, v38 op_sel:[1,1,0] op_sel_hi:[0,1,1] neg_hi:[0,1,0]
    v_pk_fma_f16 v39, v137, v81, v39 op_sel:[1,1,0] op_sel_hi:[0,1,1] neg_hi:[0,1,0]
    ds_write_addtid_b32 v36 offset:5440
    ds_write_addtid_b32 v37 offset:5696
    ds_write_addtid_b32 v38 offset:5984
    ds_write_addtid_b32 v39 offset:6240
    v_pk_mul_f16 v40, v140, v80 op_sel:[0,0] op_sel_hi:[1,0]
    v_pk_mul_f16 v41, v141, v81 op_sel:[0,0] op_sel_hi:[1,0]
    v_pk_mul_f16 v42, v144, v80 op_sel:[0,0] op_sel_hi:[1,0]
    v_pk_mul_f16 v43, v145, v81 op_sel:[0,0] op_sel_hi:[1,0]
    v_pk_fma_f16 v40, v140, v80, v40 op_sel:[1,1,0] op_sel_hi:[0,1,1] neg_hi:[0,1,0]
    v_pk_fma_f16 v41, v141, v81, v41 op_sel:[1,1,0] op_sel_hi:[0,1,1] neg_hi:[0,1,0]
    v_pk_fma_f16 v42, v144, v80, v42 op_sel:[1,1,0] op_sel_hi:[0,1,1] neg_hi:[0,1,0]
    v_pk_fma_f16 v43, v145, v81, v43 op_sel:[1,1,0] op_sel_hi:[0,1,1] neg_hi:[0,1,0]
    ds_write_addtid_b32 v40 offset:7616
    ds_write_addtid_b32 v41 offset:7872
    ds_write_addtid_b32 v42 offset:8160
    ds_write_addtid_b32 v43 offset:8416
    ds_read_b128 v[184:187], v17 offset:0
    ds_read_b128 v[188:191], v17 offset:64
    ds_read_b128 v[192:195], v17 offset:128
    ds_read_b128 v[196:199], v17 offset:192
    ds_read_b128 v[200:203], v17 offset:256
    ds_read_b128 v[204:207], v17 offset:320
    ds_read_b128 v[208:211], v17 offset:384
    ds_read_b128 v[212:215], v17 offset:448
    v_mul_f32 v216, v216, v10
    v_lshlrev_b32 v11, 16, v11
    s_mov_b64 exec, 1
    v_add_f32 v216, v216, v11
    s_mov_b64 exec, -1
    v_mul_f32 v217, v217, v10
    v_mul_f32 v218, v218, v10
    v_mul_f32 v219, v219, v10
    v_mul_f32 v220, v220, v10
    v_mul_f32 v221, v221, v10
    v_mul_f32 v222, v222, v10
    v_mul_f32 v223, v223, v10
    s_waitcnt lgkmcnt(0)
    v_mfma_f32_16x16x32_f16 v[224:227], v[184:187], v[152:155], 0
    v_mfma_f32_16x16x32_f16 v[224:227], v[188:191], v[156:159], v[224:227]
    v_mfma_f32_16x16x32_f16 v[224:227], v[192:195], v[160:163], v[224:227]
    v_mfma_f32_16x16x32_f16 v[224:227], v[196:199], v[164:167], v[224:227]
    v_mfma_f32_16x16x32_f16 v[224:227], v[200:203], v[168:171], v[224:227]
    v_mfma_f32_16x16x32_f16 v[224:227], v[204:207], v[172:175], v[224:227]
    v_mfma_f32_16x16x32_f16 v[224:227], v[208:211], v[176:179], v[224:227]
    v_mfma_f32_16x16x32_f16 v[224:227], v[212:215], v[180:183], v[224:227]
    v_cvt_pk_bf16_f32 v60, v223, v223
    v_cvt_pk_bf16_f32 v61, v222, v222
    v_cvt_pk_bf16_f32 v62, v222, v221
    v_cvt_pk_bf16_f32 v63, v220, v220
    v_cvt_pk_bf16_f32 v64, v219, v218
    v_cvt_pk_bf16_f32 v65, v217, v216
    s_nop 1
    v_mul_f32 v226, v226, v10
    v_mul_f32 v227, v227, v10
    v_mul_f32 v224, v224, v10
    v_mul_f32 v225, v225, v10
    v_mov_b32_dpp v66, v226 quad_perm:[0,0,2,2] row_mask:0xf bank_mask:0xf
    v_mov_b32_dpp v67, v227 quad_perm:[0,0,2,2] row_mask:0xf bank_mask:0xf
    v_cvt_pk_bf16_f32 v68, v226, v226
    v_cvt_pk_bf16_f32 v69, v226, v66
    v_cvt_pk_bf16_f32 v70, v227, v227
    v_cvt_pk_bf16_f32 v71, v227, v67
    ds_write2_b32 v24, v68, v68 offset0:64 offset1:65
    ds_write2_b32 v24, v68, v69 offset0:66 offset1:67
    ds_write2_b32 v24, v70, v70 offset0:0 offset1:1
    ds_write2_b32 v24, v70, v71 offset0:2 offset1:3
    v_cvt_pk_bf16_f32 v72, v225, v225
    v_cvt_pk_bf16_f32 v73, v225, v224
    v_cvt_pk_bf16_f32 v74, v224, v224
    ds_write2_b32 v25, v72, v73 offset0:0 offset1:1
    ds_write2_b32 v25, v74, v74 offset0:2 offset1:3
    s_mov_b32 exec_lo, 0
    s_mov_b32 exec_hi, 1
    ds_write2_b32 v12, v63, v63 offset0:0 offset1:1
    s_mov_b32 exec_lo, -1
    s_mov_b32 exec_hi, 0
    ds_write_b16 v25, v60 offset:510
    ds_write2_b32 v25, v61, v62 offset0:128 offset1:129
    ds_write_b32 v25, v63 offset:520
    ds_write_b16 v25, v63 offset:524
    s_mov_b64 exec, -1
    ds_write_b64 v26, v[64:65] offset:4088
    s_cmp_eq_u32 s3, 0
    s_cbranch_scc0 L_ssm_nj
L_join2:
    s_waitcnt vmcnt(0)
    v_readfirstlane_b32 s90, v251
    s_lshl_b32 s91, s4, 6
    s_add_u32 s91, s91, s5
    s_lshl_b32 s91, s91, 2
    s_add_u32 s91, s91, 6656
    s_cmp_eq_u32 s90, 1
    s_cbranch_scc1 L_joined2
    s_sleep 4
    buffer_load_dword v251, v252, s[84:87], 0 offen sc1
    s_add_u32 s94, s94, 1
    s_cmp_lt_u32 s94, 0x100000
    s_cbranch_scc1 L_join2
L_joined2:
L_ssm_nj:
    s_waitcnt lgkmcnt(0)
    s_barrier
    s_mul_i32 s12, s3, 8704
    v_add_u32 v12, s12, v4
    s_mov_b64 exec, 0xff
    ds_write_b32 v12, v252
    ds_write_b32 v12, v252 offset:4160
    s_mov_b64 exec, -1
    s_lshl_b32 s13, s3, 9
    v_lshl_add_u32 v13, v0, 3, s13
    s_mov_b32 s14, 0x05040100
    s_mov_b32 s15, 0x07060302
    s_waitcnt vmcnt(0)
    s_nop 0
    v_mov_b32_dpp v244, v240 wave_shr:1 row_mask:0xf bank_mask:0xf
    v_mov_b32_dpp v245, v241 wave_shr:1 row_mask:0xf bank_mask:0xf
    v_mov_b32_dpp v246, v242 wave_shr:1 row_mask:0xf bank_mask:0xf
    v_mov_b32_dpp v247, v243 wave_shr:1 row_mask:0xf bank_mask:0xf
    v_perm_b32 v64, v232, v228, s14
    v_perm_b32 v65, v240, v236, s14
    v_perm_b32 v66, v228, v244, s14
    v_perm_b32 v67, v236, v232, s14
    ds_write_b64 v13, v[64:65] offset:32
    ds_write_b64 v13, v[66:67] offset:4192
    v_perm_b32 v68, v232, v228, s15
    v_perm_b32 v69, v240, v236, s15
    v_perm_b32 v70, v228, v244, s15
    v_perm_b32 v71, v236, v232, s15
    ds_write_b64 v13, v[68:69] offset:8736
    ds_write_b64 v13, v[70:71] offset:12896
    v_perm_b32 v72, v233, v229, s14
    v_perm_b32 v73, v241, v237, s14
    v_perm_b32 v74, v229, v245, s14
    v_perm_b32 v75, v237, v233, s14
    ds_write_b64 v13, v[72:73] offset:17440
    ds_write_b64 v13, v[74:75] offset:21600
    v_perm_b32 v76, v233, v229, s15
    v_perm_b32 v77, v241, v237, s15
    v_perm_b32 v78, v229, v245, s15
    v_perm_b32 v79, v237, v233, s15
    ds_write_b64 v13, v[76:77] offset:26144
    ds_write_b64 v13, v[78:79] offset:30304
    v_perm_b32 v80, v234, v230, s14
    v_perm_b32 v81, v242, v238, s14
    v_perm_b32 v82, v230, v246, s14
    v_perm_b32 v83, v238, v234, s14
    ds_write_b64 v13, v[80:81] offset:34848
    ds_write_b64 v13, v[82:83] offset:39008
    v_perm_b32 v84, v234, v230, s15
    v_perm_b32 v85, v242, v238, s15
    v_perm_b32 v86, v230, v246, s15
    v_perm_b32 v87, v238, v234, s15
    ds_write_b64 v13, v[84:85] offset:43552
    ds_write_b64 v13, v[86:87] offset:47712
    v_perm_b32 v88, v235, v231, s14
    v_perm_b32 v89, v243, v239, s14
    v_perm_b32 v90, v231, v247, s14
    v_perm_b32 v91, v239, v235, s14
    ds_write_b64 v13, v[88:89] offset:52256
    ds_write_b64 v13, v[90:91] offset:56416
    v_perm_b32 v92, v235, v231, s15
    v_perm_b32 v93, v243, v239, s15
    v_perm_b32 v94, v231, v247, s15
    v_perm_b32 v95, v239, v235, s15
    ds_write_b64 v13, v[92:93] offset:60960
    ds_write_b64 v13, v[94:95] offset:65120
    v_and_b32 v4, 15, v0
    v_lshrrev_b32 v5, 4, v0
    v_add_u32 v6, 1, v4
    v_and_b32 v7, 1, v6
    v_mul_u32_u24 v7, 4164, v7
    v_lshrrev_b32 v6, 1, v6
    v_lshl_add_u32 v7, v6, 2, v7
    v_lshlrev_b32 v6, 4, v5
    v_sub_u32 v7, v7, v6
    v_add_u32 v7, 48, v7
    v_add_u32 v8, s12, v7
    v_add_u32 v9, 1024, v8
    v_add_u32 v10, 2048, v8
    v_add_u32 v11, 3072, v8
    v_lshlrev_b32 v7, 5, v4
    v_add_u32 v7, v7, v6
    s_mul_i32 s13, s3, 4592
    s_add_u32 s13, s13, 70176
    v_sub_u32 v12, s13, v7
    v_mov_b32 v32, 0
    v_mov_b32 v33, 0
    v_mov_b32 v34, 0
    v_mov_b32 v35, 0
    v_mov_b32 v36, 0
    v_mov_b32 v37, 0
    v_mov_b32 v38, 0
    v_mov_b32 v39, 0
    v_mov_b32 v40, 0
    v_mov_b32 v41, 0
    v_mov_b32 v42, 0
    v_mov_b32 v43, 0
    v_mov_b32 v44, 0
    v_mov_b32 v45, 0
    v_mov_b32 v46, 0
    v_mov_b32 v47, 0
    v_mov_b32 v48, 0
    v_mov_b32 v49, 0
    v_mov_b32 v50, 0
    v_mov_b32 v51, 0
    v_mov_b32 v52, 0
    v_mov_b32 v53, 0
    v_mov_b32 v54, 0
    v_mov_b32 v55, 0
    v_mov_b32 v56, 0
    v_mov_b32 v57, 0
    v_mov_b32 v58, 0
    v_mov_b32 v59, 0
    v_mov_b32 v60, 0
    v_mov_b32 v61, 0
    v_mov_b32 v62, 0
    v_mov_b32 v63, 0
    s_add_u32 s48, s42, 0x700000
    s_addc_u32 s49, s43, 0
    s_mov_b32 s50, 0x280000
    s_mov_b32 s51, 0x00020000
    s_mov_b32 s56, s34
    s_mov_b32 s57, s35
    s_mov_b32 s58, 0x21c000
    s_mov_b32 s59, 0x00020000
    v_min_u32 v193, 59, v0
    v_mul_u32_u24 v194, 6554, v193
    v_lshrrev_b32 v194, 16, v194
    v_mul_u32_u24 v195, 10, v194
    v_sub_u32 v195, v193, v195
    v_mul_u32_u24 v193, 192, v195
    v_add_u32 v193, v193, v194
    v_lshlrev_b32 v195, 7, v195
    s_lshl_b32 s13, s77, 2
    s_and_b32 s14, s3, 3
    s_add_u32 s13, s13, s14
    s_mul_i32 s13, s13, 6
    s_add_u32 s13, s13, 768
    v_add_u32 v193, s13, v193
    v_add_u32 v196, 0, v193
    v_subrev_u32 v194, 1728, v196
    v_min_u32 v196, v196, v194
    v_mul_u32_u24 v196, 1280, v196
    v_add_u32 v196, v196, v195
    v_add_u32 v197, 240, v193
    v_subrev_u32 v194, 1728, v197
    v_min_u32 v197, v197, v194
    v_mul_u32_u24 v197, 1280, v197
    v_add_u32 v197, v197, v195
    v_add_u32 v198, 480, v193
    v_subrev_u32 v194, 1728, v198
    v_min_u32 v198, v198, v194
    v_mul_u32_u24 v198, 1280, v198
    v_add_u32 v198, v198, v195
    v_add_u32 v199, 720, v193
    v_subrev_u32 v194, 1728, v199
    v_min_u32 v199, v199, v194
    v_mul_u32_u24 v199, 1280, v199
    v_add_u32 v199, v199, v195
    s_cmp_ge_u32 s3, 4
    s_cselect_b32 s14, 3, 0
    s_waitcnt lgkmcnt(0)
    s_barrier
    ds_read_b128 v[96:99], v12 offset:3584
    ds_read2_b32 v[64:65], v8 offset0:0 offset1:1
    ds_read2_b32 v[66:67], v8 offset0:2 offset1:3
    ds_read_b128 v[100:103], v12 offset:3072
    ds_read2_b32 v[68:69], v8 offset0:128 offset1:129
    ds_read2_b32 v[70:71], v8 offset0:130 offset1:131
    ds_read_b128 v[104:107], v12 offset:2560
    ds_read2_b32 v[72:73], v9 offset0:0 offset1:1
    ds_read2_b32 v[74:75], v9 offset0:2 offset1:3
    ds_read_b128 v[108:111], v12 offset:2048
    ds_read2_b32 v[76:77], v9 offset0:128 offset1:129
    ds_read2_b32 v[78:79], v9 offset0:130 offset1:131
    ds_read_b128 v[112:115], v12 offset:1536
    ds_read2_b32 v[80:81], v10 offset0:0 offset1:1
    ds_read2_b32 v[82:83], v10 offset0:2 offset1:3
    ds_read_b128 v[116:119], v12 offset:1024
    ds_read2_b32 v[84:85], v10 offset0:128 offset1:129
    ds_read2_b32 v[86:87], v10 offset0:130 offset1:131
    ds_read_b128 v[120:123], v12 offset:512
    ds_read2_b32 v[88:89], v11 offset0:0 offset1:1
    ds_read2_b32 v[90:91], v11 offset0:2 offset1:3
    ds_read_b128 v[124:127], v12 offset:0
    ds_read2_b32 v[92:93], v11 offset0:128 offset1:129
    ds_read2_b32 v[94:95], v11 offset0:130 offset1:131
    s_mov_b32 s15, 0
    s_waitcnt lgkmcnt(0)
L_conv_loop:
    s_cmp_eq_u32 s15, s14
    s_cbranch_scc0 L_conv_np
    s_cmp_ge_u32 s3, 4
    s_cbranch_scc1 L_conv_hi
    buffer_load_dword v200, v196, s[56:59], 0 offen
    s_branch L_conv_np
L_conv_hi:
    buffer_load_dword v201, v197, s[56:59], 0 offen
    buffer_load_dword v202, v198, s[56:59], 0 offen
    buffer_load_dword v203, v199, s[56:59], 0 offen
L_conv_np:
    v_mfma_f32_16x16x32_bf16 v[32:35], v[64:67], v[96:99], v[32:35]
    v_add_u32 v8, 64, v8
    v_mfma_f32_16x16x32_bf16 v[36:39], v[64:67], v[100:103], v[36:39]
    v_add_u32 v9, 64, v9
    v_mfma_f32_16x16x32_bf16 v[40:43], v[64:67], v[104:107], v[40:43]
    v_add_u32 v10, 64, v10
    v_mfma_f32_16x16x32_bf16 v[44:47], v[64:67], v[108:111], v[44:47]
    v_add_u32 v11, 64, v11
    v_mfma_f32_16x16x32_bf16 v[48:51], v[64:67], v[112:115], v[48:51]
    v_add_u32 v12, 64, v12
    v_mfma_f32_16x16x32_bf16 v[52:55], v[64:67], v[116:119], v[52:55]
    ds_read_b128 v[160:163], v12 offset:3584
    v_mfma_f32_16x16x32_bf16 v[56:59], v[64:67], v[120:123], v[56:59]
    ds_read2_b32 v[128:129], v8 offset0:0 offset1:1
    v_mfma_f32_16x16x32_bf16 v[60:63], v[64:67], v[124:127], v[60:63]
    ds_read2_b32 v[130:131], v8 offset0:2 offset1:3
    v_mfma_f32_16x16x32_bf16 v[36:39], v[68:71], v[96:99], v[36:39]
    ds_read_b128 v[164:167], v12 offset:3072
    v_mfma_f32_16x16x32_bf16 v[40:43], v[68:71], v[100:103], v[40:43]
    ds_read2_b32 v[132:133], v8 offset0:128 offset1:129
    v_mfma_f32_16x16x32_bf16 v[44:47], v[68:71], v[104:107], v[44:47]
    ds_read2_b32 v[134:135], v8 offset0:130 offset1:131
    v_mfma_f32_16x16x32_bf16 v[48:51], v[68:71], v[108:111], v[48:51]
    ds_read_b128 v[168:171], v12 offset:2560
    v_mfma_f32_16x16x32_bf16 v[52:55], v[68:71], v[112:115], v[52:55]
    ds_read2_b32 v[136:137], v9 offset0:0 offset1:1
    v_mfma_f32_16x16x32_bf16 v[56:59], v[68:71], v[116:119], v[56:59]
    ds_read2_b32 v[138:139], v9 offset0:2 offset1:3
    v_mfma_f32_16x16x32_bf16 v[60:63], v[68:71], v[120:123], v[60:63]
    ds_read_b128 v[172:175], v12 offset:2048
    v_mfma_f32_16x16x32_bf16 v[40:43], v[72:75], v[96:99], v[40:43]
    ds_read2_b32 v[140:141], v9 offset0:128 offset1:129
    v_mfma_f32_16x16x32_bf16 v[44:47], v[72:75], v[100:103], v[44:47]
    ds_read2_b32 v[142:143], v9 offset0:130 offset1:131
    v_mfma_f32_16x16x32_bf16 v[48:51], v[72:75], v[104:107], v[48:51]
    ds_read_b128 v[176:179], v12 offset:1536
    v_mfma_f32_16x16x32_bf16 v[52:55], v[72:75], v[108:111], v[52:55]
    ds_read2_b32 v[144:145], v10 offset0:0 offset1:1
    v_mfma_f32_16x16x32_bf16 v[56:59], v[72:75], v[112:115], v[56:59]
    ds_read2_b32 v[146:147], v10 offset0:2 offset1:3
    v_mfma_f32_16x16x32_bf16 v[60:63], v[72:75], v[116:119], v[60:63]
    ds_read_b128 v[180:183], v12 offset:1024
    v_mfma_f32_16x16x32_bf16 v[44:47], v[76:79], v[96:99], v[44:47]
    ds_read2_b32 v[148:149], v10 offset0:128 offset1:129
    v_mfma_f32_16x16x32_bf16 v[48:51], v[76:79], v[100:103], v[48:51]
    ds_read2_b32 v[150:151], v10 offset0:130 offset1:131
    v_mfma_f32_16x16x32_bf16 v[52:55], v[76:79], v[104:107], v[52:55]
    ds_read_b128 v[184:187], v12 offset:512
    v_mfma_f32_16x16x32_bf16 v[56:59], v[76:79], v[108:111], v[56:59]
    ds_read2_b32 v[152:153], v11 offset0:0 offset1:1
    v_mfma_f32_16x16x32_bf16 v[60:63], v[76:79], v[112:115], v[60:63]
    ds_read2_b32 v[154:155], v11 offset0:2 offset1:3
    v_mfma_f32_16x16x32_bf16 v[48:51], v[80:83], v[96:99], v[48:51]
    ds_read_b128 v[188:191], v12 offset:0
    v_mfma_f32_16x16x32_bf16 v[52:55], v[80:83], v[100:103], v[52:55]
    ds_read2_b32 v[156:157], v11 offset0:128 offset1:129
    v_mfma_f32_16x16x32_bf16 v[56:59], v[80:83], v[104:107], v[56:59]
    ds_read2_b32 v[158:159], v11 offset0:130 offset1:131
    v_mfma_f32_16x16x32_bf16 v[60:63], v[80:83], v[108:111], v[60:63]
    v_mfma_f32_16x16x32_bf16 v[52:55], v[84:87], v[96:99], v[52:55]
    v_mfma_f32_16x16x32_bf16 v[56:59], v[84:87], v[100:103], v[56:59]
    v_mfma_f32_16x16x32_bf16 v[60:63], v[84:87], v[104:107], v[60:63]
    v_mfma_f32_16x16x32_bf16 v[56:59], v[88:91], v[96:99], v[56:59]
    v_mfma_f32_16x16x32_bf16 v[60:63], v[88:91], v[100:103], v[60:63]
    v_mfma_f32_16x16x32_bf16 v[60:63], v[92:95], v[96:99], v[60:63]
    s_waitcnt lgkmcnt(0)
    v_mfma_f32_16x16x32_bf16 v[32:35], v[128:131], v[160:163], v[32:35]
    v_add_u32 v8, 64, v8
    v_mfma_f32_16x16x32_bf16 v[36:39], v[128:131], v[164:167], v[36:39]
    v_add_u32 v9, 64, v9
    v_mfma_f32_16x16x32_bf16 v[40:43], v[128:131], v[168:171], v[40:43]
    v_add_u32 v10, 64, v10
    v_mfma_f32_16x16x32_bf16 v[44:47], v[128:131], v[172:175], v[44:47]
    v_add_u32 v11, 64, v11
    v_mfma_f32_16x16x32_bf16 v[48:51], v[128:131], v[176:179], v[48:51]
    v_add_u32 v12, 64, v12
    v_mfma_f32_16x16x32_bf16 v[52:55], v[128:131], v[180:183], v[52:55]
    ds_read_b128 v[96:99], v12 offset:3584
    v_mfma_f32_16x16x32_bf16 v[56:59], v[128:131], v[184:187], v[56:59]
    ds_read2_b32 v[64:65], v8 offset0:0 offset1:1
    v_mfma_f32_16x16x32_bf16 v[60:63], v[128:131], v[188:191], v[60:63]
    ds_read2_b32 v[66:67], v8 offset0:2 offset1:3
    v_mfma_f32_16x16x32_bf16 v[36:39], v[132:135], v[160:163], v[36:39]
    ds_read_b128 v[100:103], v12 offset:3072
    v_mfma_f32_16x16x32_bf16 v[40:43], v[132:135], v[164:167], v[40:43]
    ds_read2_b32 v[68:69], v8 offset0:128 offset1:129
    v_mfma_f32_16x16x32_bf16 v[44:47], v[132:135], v[168:171], v[44:47]
    ds_read2_b32 v[70:71], v8 offset0:130 offset1:131
    v_mfma_f32_16x16x32_bf16 v[48:51], v[132:135], v[172:175], v[48:51]
    ds_read_b128 v[104:107], v12 offset:2560
    v_mfma_f32_16x16x32_bf16 v[52:55], v[132:135], v[176:179], v[52:55]
    ds_read2_b32 v[72:73], v9 offset0:0 offset1:1
    v_mfma_f32_16x16x32_bf16 v[56:59], v[132:135], v[180:183], v[56:59]
    ds_read2_b32 v[74:75], v9 offset0:2 offset1:3
    v_mfma_f32_16x16x32_bf16 v[60:63], v[132:135], v[184:187], v[60:63]
    ds_read_b128 v[108:111], v12 offset:2048
    v_mfma_f32_16x16x32_bf16 v[40:43], v[136:139], v[160:163], v[40:43]
    ds_read2_b32 v[76:77], v9 offset0:128 offset1:129
    v_mfma_f32_16x16x32_bf16 v[44:47], v[136:139], v[164:167], v[44:47]
    ds_read2_b32 v[78:79], v9 offset0:130 offset1:131
    v_mfma_f32_16x16x32_bf16 v[48:51], v[136:139], v[168:171], v[48:51]
    ds_read_b128 v[112:115], v12 offset:1536
    v_mfma_f32_16x16x32_bf16 v[52:55], v[136:139], v[172:175], v[52:55]
    ds_read2_b32 v[80:81], v10 offset0:0 offset1:1
    v_mfma_f32_16x16x32_bf16 v[56:59], v[136:139], v[176:179], v[56:59]
    ds_read2_b32 v[82:83], v10 offset0:2 offset1:3
    v_mfma_f32_16x16x32_bf16 v[60:63], v[136:139], v[180:183], v[60:63]
    ds_read_b128 v[116:119], v12 offset:1024
    v_mfma_f32_16x16x32_bf16 v[44:47], v[140:143], v[160:163], v[44:47]
    ds_read2_b32 v[84:85], v10 offset0:128 offset1:129
    v_mfma_f32_16x16x32_bf16 v[48:51], v[140:143], v[164:167], v[48:51]
    ds_read2_b32 v[86:87], v10 offset0:130 offset1:131
    v_mfma_f32_16x16x32_bf16 v[52:55], v[140:143], v[168:171], v[52:55]
    ds_read_b128 v[120:123], v12 offset:512
    v_mfma_f32_16x16x32_bf16 v[56:59], v[140:143], v[172:175], v[56:59]
    ds_read2_b32 v[88:89], v11 offset0:0 offset1:1
    v_mfma_f32_16x16x32_bf16 v[60:63], v[140:143], v[176:179], v[60:63]
    ds_read2_b32 v[90:91], v11 offset0:2 offset1:3
    v_mfma_f32_16x16x32_bf16 v[48:51], v[144:147], v[160:163], v[48:51]
    ds_read_b128 v[124:127], v12 offset:0
    v_mfma_f32_16x16x32_bf16 v[52:55], v[144:147], v[164:167], v[52:55]
    ds_read2_b32 v[92:93], v11 offset0:128 offset1:129
    v_mfma_f32_16x16x32_bf16 v[56:59], v[144:147], v[168:171], v[56:59]
    ds_read2_b32 v[94:95], v11 offset0:130 offset1:131
    v_mfma_f32_16x16x32_bf16 v[60:63], v[144:147], v[172:175], v[60:63]
    v_mfma_f32_16x16x32_bf16 v[52:55], v[148:151], v[160:163], v[52:55]
    v_mfma_f32_16x16x32_bf16 v[56:59], v[148:151], v[164:167], v[56:59]
    v_mfma_f32_16x16x32_bf16 v[60:63], v[148:151], v[168:171], v[60:63]
    v_mfma_f32_16x16x32_bf16 v[56:59], v[152:155], v[160:163], v[56:59]
    v_mfma_f32_16x16x32_bf16 v[60:63], v[152:155], v[164:167], v[60:63]
    v_mfma_f32_16x16x32_bf16 v[60:63], v[156:159], v[160:163], v[60:63]
    s_waitcnt lgkmcnt(0)
    s_add_u32 s15, s15, 1
    s_cmp_lt_u32 s15, 4
    s_cbranch_scc1 L_conv_loop
    v_lshlrev_b32 v14, 5, v4
    v_lshrrev_b32 v6, 1, v5
    v_lshl_add_u32 v14, v6, 4, v14
    v_and_b32 v6, 1, v5
    v_lshl_add_u32 v14, v6, 9, v14
    s_lshl_b32 s11, s7, 12
    s_nop 0
    v_cvt_pk_bf16_f32 v64, v32, v33
    v_cvt_pk_bf16_f32 v65, v34, v35
    v_cvt_pk_bf16_f32 v66, v36, v37
    v_cvt_pk_bf16_f32 v67, v38, v39
    s_nop 1
    v_permlane16_swap_b32 v64, v66
    v_permlane16_swap_b32 v65, v67
    buffer_store_dwordx4 v[64:67], v14, s[48:51], s11 offen offset:0 sc1
    v_cvt_pk_bf16_f32 v68, v40, v41
    v_cvt_pk_bf16_f32 v69, v42, v43
    v_cvt_pk_bf16_f32 v70, v44, v45
    v_cvt_pk_bf16_f32 v71, v46, v47
    s_nop 1
    v_permlane16_swap_b32 v68, v70
    v_permlane16_swap_b32 v69, v71
    buffer_store_dwordx4 v[68:71], v14, s[48:51], s11 offen offset:1024 sc1
    v_cvt_pk_bf16_f32 v72, v48, v49
    v_cvt_pk_bf16_f32 v73, v50, v51
    v_cvt_pk_bf16_f32 v74, v52, v53
    v_cvt_pk_bf16_f32 v75, v54, v55
    s_nop 1
    v_permlane16_swap_b32 v72, v74
    v_permlane16_swap_b32 v73, v75
    buffer_store_dwordx4 v[72:75], v14, s[48:51], s11 offen offset:2048 sc1
    v_cvt_pk_bf16_f32 v76, v56, v57
    v_cvt_pk_bf16_f32 v77, v58, v59
    v_cvt_pk_bf16_f32 v78, v60, v61
    v_cvt_pk_bf16_f32 v79, v62, v63
    s_nop 1
    v_permlane16_swap_b32 v76, v78
    v_permlane16_swap_b32 v77, v79
    buffer_store_dwordx4 v[76:79], v14, s[48:51], s11 offen offset:3072 sc1
    s_cmp_lt_u32 s3, 4
    s_cbranch_scc0 L_ssm_fin
    s_mov_b32 s52, s36
    s_mov_b32 s53, s37
    s_mov_b32 s54, 0x500
    s_mov_b32 s55, 0x00020000
    s_add_u32 s60, s42, 0x980000
    s_addc_u32 s61, s43, 0
    s_mov_b32 s62, 0x2000
    s_mov_b32 s63, 0x00020000
    s_lshl_b32 s9, s77, 2
    s_add_u32 s9, s9, s3
    s_lshl_b32 s10, s4, 5
    s_add_u32 s10, s10, s9
    s_lshl_b32 s10, s10, 3
    v_lshlrev_b32 v3, 4, v4
    v_mul_u32_u24 v6, 1280, v5
    v_add_u32 v6, v6, v3
    s_mul_i32 s11, s10, 1280
    s_add_u32 s12, s11, 5120
    s_cmp_lt_u32 s77, 8
    s_cbranch_scc0 L_ssm_fin
    buffer_load_dwordx4 v[140:143], v3, s[52:55], 0 offen offset:0
    buffer_load_dwordx4 v[144:147], v3, s[52:55], 0 offen offset:256
    buffer_load_dwordx4 v[148:151], v3, s[52:55], 0 offen offset:512
    buffer_load_dwordx4 v[152:155], v3, s[52:55], 0 offen offset:768
    buffer_load_dwordx4 v[156:159], v3, s[52:55], 0 offen offset:1024
    buffer_load_dwordx4 v[100:103], v6, s[72:75], s11 offen offset:0
    buffer_load_dwordx4 v[104:107], v6, s[72:75], s11 offen offset:256
    buffer_load_dwordx4 v[108:111], v6, s[72:75], s11 offen offset:512
    buffer_load_dwordx4 v[112:115], v6, s[72:75], s11 offen offset:768
    buffer_load_dwordx4 v[116:119], v6, s[72:75], s11 offen offset:1024
    buffer_load_dwordx4 v[120:123], v6, s[72:75], s12 offen offset:0
    buffer_load_dwordx4 v[124:127], v6, s[72:75], s12 offen offset:256
    buffer_load_dwordx4 v[128:131], v6, s[72:75], s12 offen offset:512
    buffer_load_dwordx4 v[132:135], v6, s[72:75], s12 offen offset:768
    buffer_load_dwordx4 v[136:139], v6, s[72:75], s12 offen offset:1024
    s_mov_b32 s13, 0xffff0000
    v_lshlrev_b32 v2, 2, v5
    s_lshl_b32 s10, s10, 2
    s_waitcnt vmcnt(10)
    v_lshlrev_b32 v160, 16, v140
    v_and_b32 v161, s13, v140
    v_lshlrev_b32 v162, 16, v141
    v_and_b32 v163, s13, v141
    v_lshlrev_b32 v164, 16, v142
    v_and_b32 v165, s13, v142
    v_lshlrev_b32 v166, 16, v143
    v_and_b32 v167, s13, v143
    v_lshlrev_b32 v168, 16, v144
    v_and_b32 v169, s13, v144
    v_lshlrev_b32 v170, 16, v145
    v_and_b32 v171, s13, v145
    v_lshlrev_b32 v172, 16, v146
    v_and_b32 v173, s13, v146
    v_lshlrev_b32 v174, 16, v147
    v_and_b32 v175, s13, v147
    v_lshlrev_b32 v176, 16, v148
    v_and_b32 v177, s13, v148
    v_lshlrev_b32 v178, 16, v149
    v_and_b32 v179, s13, v149
    v_lshlrev_b32 v180, 16, v150
    v_and_b32 v181, s13, v150
    v_lshlrev_b32 v182, 16, v151
    v_and_b32 v183, s13, v151
    v_lshlrev_b32 v184, 16, v152
    v_and_b32 v185, s13, v152
    v_lshlrev_b32 v186, 16, v153
    v_and_b32 v187, s13, v153
    v_lshlrev_b32 v188, 16, v154
    v_and_b32 v189, s13, v154
    v_lshlrev_b32 v190, 16, v155
    v_and_b32 v191, s13, v155
    v_lshlrev_b32 v192, 16, v156
    v_and_b32 v193, s13, v156
    v_lshlrev_b32 v194, 16, v157
    v_and_b32 v195, s13, v157
    v_lshlrev_b32 v196, 16, v158
    v_and_b32 v197, s13, v158
    v_lshlrev_b32 v198, 16, v159
    v_and_b32 v199, s13, v159
    s_mov_b32 s14, 0
    s_waitcnt vmcnt(0)
L_gate:
    v_mov_b32 v8, 0
    v_mov_b32 v9, 0
    v_lshlrev_b32 v10, 16, v100
    v_and_b32 v11, s13, v100
    v_mul_f32 v10, v10, v160
    v_mul_f32 v11, v11, v161
    v_cvt_pk_bf16_f32 v10, v10, v11
    v_mov_b32 v100, v120
    v_and_b32 v11, s13, v10
    v_lshlrev_b32 v10, 16, v10
    v_add_f32 v9, v9, v11
    v_add_f32 v8, v8, v10
    v_lshlrev_b32 v10, 16, v101
    v_and_b32 v11, s13, v101
    v_mul_f32 v10, v10, v162
    v_mul_f32 v11, v11, v163
    v_cvt_pk_bf16_f32 v10, v10, v11
    v_mov_b32 v101, v121
    v_and_b32 v11, s13, v10
    v_lshlrev_b32 v10, 16, v10
    v_add_f32 v9, v9, v11
    v_add_f32 v8, v8, v10
    v_lshlrev_b32 v10, 16, v102
    v_and_b32 v11, s13, v102
    v_mul_f32 v10, v10, v164
    v_mul_f32 v11, v11, v165
    v_cvt_pk_bf16_f32 v10, v10, v11
    v_mov_b32 v102, v122
    v_and_b32 v11, s13, v10
    v_lshlrev_b32 v10, 16, v10
    v_add_f32 v9, v9, v11
    v_add_f32 v8, v8, v10
    v_lshlrev_b32 v10, 16, v103
    v_and_b32 v11, s13, v103
    v_mul_f32 v10, v10, v166
    v_mul_f32 v11, v11, v167
    v_cvt_pk_bf16_f32 v10, v10, v11
    v_mov_b32 v103, v123
    v_and_b32 v11, s13, v10
    v_lshlrev_b32 v10, 16, v10
    v_add_f32 v9, v9, v11
    v_add_f32 v8, v8, v10
    v_lshlrev_b32 v10, 16, v104
    v_and_b32 v11, s13, v104
    v_mul_f32 v10, v10, v168
    v_mul_f32 v11, v11, v169
    v_cvt_pk_bf16_f32 v10, v10, v11
    v_mov_b32 v104, v124
    v_and_b32 v11, s13, v10
    v_lshlrev_b32 v10, 16, v10
    v_add_f32 v9, v9, v11
    v_add_f32 v8, v8, v10
    v_lshlrev_b32 v10, 16, v105
    v_and_b32 v11, s13, v105
    v_mul_f32 v10, v10, v170
    v_mul_f32 v11, v11, v171
    v_cvt_pk_bf16_f32 v10, v10, v11
    v_mov_b32 v105, v125
    v_and_b32 v11, s13, v10
    v_lshlrev_b32 v10, 16, v10
    v_add_f32 v9, v9, v11
    v_add_f32 v8, v8, v10
    v_lshlrev_b32 v10, 16, v106
    v_and_b32 v11, s13, v106
    v_mul_f32 v10, v10, v172
    v_mul_f32 v11, v11, v173
    v_cvt_pk_bf16_f32 v10, v10, v11
    v_mov_b32 v106, v126
    v_and_b32 v11, s13, v10
    v_lshlrev_b32 v10, 16, v10
    v_add_f32 v9, v9, v11
    v_add_f32 v8, v8, v10
    v_lshlrev_b32 v10, 16, v107
    v_and_b32 v11, s13, v107
    v_mul_f32 v10, v10, v174
    v_mul_f32 v11, v11, v175
    v_cvt_pk_bf16_f32 v10, v10, v11
    v_mov_b32 v107, v127
    v_and_b32 v11, s13, v10
    v_lshlrev_b32 v10, 16, v10
    v_add_f32 v9, v9, v11
    v_add_f32 v8, v8, v10
    v_lshlrev_b32 v10, 16, v108
    v_and_b32 v11, s13, v108
    v_mul_f32 v10, v10, v176
    v_mul_f32 v11, v11, v177
    v_cvt_pk_bf16_f32 v10, v10, v11
    v_mov_b32 v108, v128
    v_and_b32 v11, s13, v10
    v_lshlrev_b32 v10, 16, v10
    v_add_f32 v9, v9, v11
    v_add_f32 v8, v8, v10
    v_lshlrev_b32 v10, 16, v109
    v_and_b32 v11, s13, v109
    v_mul_f32 v10, v10, v178
    v_mul_f32 v11, v11, v179
    v_cvt_pk_bf16_f32 v10, v10, v11
    v_mov_b32 v109, v129
    v_and_b32 v11, s13, v10
    v_lshlrev_b32 v10, 16, v10
    v_add_f32 v9, v9, v11
    v_add_f32 v8, v8, v10
    v_lshlrev_b32 v10, 16, v110
    v_and_b32 v11, s13, v110
    v_mul_f32 v10, v10, v180
    v_mul_f32 v11, v11, v181
    v_cvt_pk_bf16_f32 v10, v10, v11
    v_mov_b32 v110, v130
    v_and_b32 v11, s13, v10
    v_lshlrev_b32 v10, 16, v10
    v_add_f32 v9, v9, v11
    v_add_f32 v8, v8, v10
    v_lshlrev_b32 v10, 16, v111
    v_and_b32 v11, s13, v111
    v_mul_f32 v10, v10, v182
    v_mul_f32 v11, v11, v183
    v_cvt_pk_bf16_f32 v10, v10, v11
    v_mov_b32 v111, v131
    v_and_b32 v11, s13, v10
    v_lshlrev_b32 v10, 16, v10
    v_add_f32 v9, v9, v11
    v_add_f32 v8, v8, v10
    v_lshlrev_b32 v10, 16, v112
    v_and_b32 v11, s13, v112
    v_mul_f32 v10, v10, v184
    v_mul_f32 v11, v11, v185
    v_cvt_pk_bf16_f32 v10, v10, v11
    v_mov_b32 v112, v132
    v_and_b32 v11, s13, v10
    v_lshlrev_b32 v10, 16, v10
    v_add_f32 v9, v9, v11
    v_add_f32 v8, v8, v10
    v_lshlrev_b32 v10, 16, v113
    v_and_b32 v11, s13, v113
    v_mul_f32 v10, v10, v186
    v_mul_f32 v11, v11, v187
    v_cvt_pk_bf16_f32 v10, v10, v11
    v_mov_b32 v113, v133
    v_and_b32 v11, s13, v10
    v_lshlrev_b32 v10, 16, v10
    v_add_f32 v9, v9, v11
    v_add_f32 v8, v8, v10
    v_lshlrev_b32 v10, 16, v114
    v_and_b32 v11, s13, v114
    v_mul_f32 v10, v10, v188
    v_mul_f32 v11, v11, v189
    v_cvt_pk_bf16_f32 v10, v10, v11
    v_mov_b32 v114, v134
    v_and_b32 v11, s13, v10
    v_lshlrev_b32 v10, 16, v10
    v_add_f32 v9, v9, v11
    v_add_f32 v8, v8, v10
    v_lshlrev_b32 v10, 16, v115
    v_and_b32 v11, s13, v115
    v_mul_f32 v10, v10, v190
    v_mul_f32 v11, v11, v191
    v_cvt_pk_bf16_f32 v10, v10, v11
    v_mov_b32 v115, v135
    v_and_b32 v11, s13, v10
    v_lshlrev_b32 v10, 16, v10
    v_add_f32 v9, v9, v11
    v_add_f32 v8, v8, v10
    v_lshlrev_b32 v10, 16, v116
    v_and_b32 v11, s13, v116
    v_mul_f32 v10, v10, v192
    v_mul_f32 v11, v11, v193
    v_cvt_pk_bf16_f32 v10, v10, v11
    v_mov_b32 v116, v136
    v_and_b32 v11, s13, v10
    v_lshlrev_b32 v10, 16, v10
    v_add_f32 v9, v9, v11
    v_add_f32 v8, v8, v10
    v_lshlrev_b32 v10, 16, v117
    v_and_b32 v11, s13, v117
    v_mul_f32 v10, v10, v194
    v_mul_f32 v11, v11, v195
    v_cvt_pk_bf16_f32 v10, v10, v11
    v_mov_b32 v117, v137
    v_and_b32 v11, s13, v10
    v_lshlrev_b32 v10, 16, v10
    v_add_f32 v9, v9, v11
    v_add_f32 v8, v8, v10
    v_lshlrev_b32 v10, 16, v118
    v_and_b32 v11, s13, v118
    v_mul_f32 v10, v10, v196
    v_mul_f32 v11, v11, v197
    v_cvt_pk_bf16_f32 v10, v10, v11
    v_mov_b32 v118, v138
    v_and_b32 v11, s13, v10
    v_lshlrev_b32 v10, 16, v10
    v_add_f32 v9, v9, v11
    v_add_f32 v8, v8, v10
    v_lshlrev_b32 v10, 16, v119
    v_and_b32 v11, s13, v119
    v_mul_f32 v10, v10, v198
    v_mul_f32 v11, v11, v199
    v_cvt_pk_bf16_f32 v10, v10, v11
    v_mov_b32 v119, v139
    v_and_b32 v11, s13, v10
    v_lshlrev_b32 v10, 16, v10
    v_add_f32 v9, v9, v11
    v_add_f32 v8, v8, v10
    v_add_f32 v8, v8, v9
    s_nop 1
    v_add_f32_dpp v8, v8, v8 row_ror:8 row_mask:0xf bank_mask:0xf
    s_nop 1
    v_add_f32_dpp v8, v8, v8 row_ror:4 row_mask:0xf bank_mask:0xf
    s_nop 1
    v_add_f32_dpp v8, v8, v8 row_ror:2 row_mask:0xf bank_mask:0xf
    s_nop 1
    v_add_f32_dpp v8, v8, v8 row_ror:1 row_mask:0xf bank_mask:0xf
    s_nop 1
    v_cvt_pk_bf16_f32 v8, v8, v8
    v_lshlrev_b32 v8, 16, v8
    v_mul_f32 v8, 0xbfb8aa3b, v8
    v_exp_f32 v8, v8
    s_nop 0
    v_add_f32 v8, 1.0, v8
    v_rcp_f32 v8, v8
    s_nop 0
    v_cvt_pk_bf16_f32 v8, v8, v8
    v_lshlrev_b32 v12, 16, v8
    buffer_store_dword v12, v2, s[60:63], s10 offen sc1
    s_add_u32 s10, s10, 16
    s_add_u32 s14, s14, 1
    s_cmp_lt_u32 s14, 2
    s_cbranch_scc1 L_gate
L_ssm_fin:
    s_lshr_b32 s12, s6, 6
    s_lshl_b32 s12, s12, 8
    s_bfe_u32 s13, s6, 0x30003
    s_lshl_b32 s13, s13, 2
    s_add_u32 s12, s12, s13
    s_add_u32 s12, s12, 4096
    s_waitcnt vmcnt(0)
    s_barrier
    s_cmp_eq_u32 s3, 0
    s_cbranch_scc0 L_ssm_end
    v_mov_b32 v253, 1
    s_mov_b64 exec, 1
    buffer_store_dword v253, v252, s[96:99], s12 offen sc1
    s_mov_b64 exec, -1
L_ssm_end:
    s_endpgm
L_end:
L_code_end:
    s_endpgm
.section .rodata,"a"
.p2align 6
.amdhsa_kernel gated_mix__ssm_conv_s4d__dense_activation_relu__prompt_kernel
  .amdhsa_next_free_vgpr 256
  .amdhsa_next_free_sgpr 102
  .amdhsa_accum_offset 256
  .amdhsa_group_segment_fixed_size 0
  .amdhsa_kernarg_size 112
  .amdhsa_user_sgpr_count 2
  .amdhsa_user_sgpr_kernarg_segment_ptr 1
  .amdhsa_system_sgpr_workgroup_id_x 1
.end_amdhsa_kernel
```
